```python
import torch

def _softmax(x, axis=-1):
    return torch.softmax(x, dim=axis)
def _gelu(x):
    return torch.nn.functional.gelu(x, approximate="tanh")
def _silu(x):
    return torch.nn.functional.silu(x)
def _sigmoid(x):
    return torch.sigmoid(x)
def _layernorm(x, axis=-1, eps=1e-5):
    m = x.mean(dim=axis, keepdim=True)
    v = x.var(dim=axis, keepdim=True, unbiased=False)
    return (x - m) / torch.sqrt(v + eps)
def _scatter_add(tgt, idx, src, axis=0):
    return tgt.clone().index_add_(axis, idx, src)
def _segment_sum(src, seg, n):
    out = torch.zeros((n,) + src.shape[1:], dtype=src.dtype)
    return out.index_add_(0, seg, src)
def _pad(x, pw):
    flat = tuple(v for pair in reversed(pw) for v in pair)
    return torch.nn.functional.pad(x, flat)

kernel_name = 'concat_heads__mha_block_cached__mha_block_cached__near_ridge'

def setup_inputs():

    _w = (lambda a: (lambda t: t.to(torch.bfloat16) if t.is_floating_point() else t)(torch.as_tensor(a)))
    def _A_setup():
        B, Sq, D = 8, 144, 512
        H, Sk, Dh = 32, 1024, 128
        return {
            "x": _w((lambda *s: torch.randn(*s, dtype=torch.bfloat16) * 0.8)(B, Sq, D)),
            "k_cache": _w((lambda *s: torch.randn(*s, dtype=torch.bfloat16) * 0.8)(B, H, Sk, Dh)),
            "v_cache": _w((lambda *s: torch.randn(*s, dtype=torch.bfloat16) * 0.05)(B, H, Sk, Dh)),
            "wq": _w((lambda *s: torch.randn(*s, dtype=torch.bfloat16) * 0.8)(D, H * Dh) * (D ** -0.5)),
            "wo": _w((lambda *s: torch.randn(*s, dtype=torch.bfloat16) * 0.05)(H * Dh, D) * ((H * Dh) ** -0.5)),
        }
    _A_in = _A_setup()

    def _B_setup():
        B, Sq, D = 8, 144, 512
        H, Sk, Dh = 32, 1024, 128
        return {
            "x": _w((lambda *s: torch.randn(*s, dtype=torch.bfloat16) * 0.8)(B, Sq, D)),
            "k_cache": _w((lambda *s: torch.randn(*s, dtype=torch.bfloat16) * 0.8)(B, H, Sk, Dh)),
            "v_cache": _w((lambda *s: torch.randn(*s, dtype=torch.bfloat16) * 0.05)(B, H, Sk, Dh)),
            "wq": _w((lambda *s: torch.randn(*s, dtype=torch.bfloat16) * 0.8)(D, H * Dh) * (D ** -0.5)),
            "wo": _w((lambda *s: torch.randn(*s, dtype=torch.bfloat16) * 0.05)(H * Dh, D) * ((H * Dh) ** -0.5)),
        }
    _B_in = _B_setup()

    return {
        "A_x": _A_in["x"],
        "A_k_cache": _A_in["k_cache"],
        "A_v_cache": _A_in["v_cache"],
        "A_wq": _A_in["wq"],
        "A_wo": _A_in["wo"],
        "B_x": _B_in["x"],
        "B_k_cache": _B_in["k_cache"],
        "B_v_cache": _B_in["v_cache"],
        "B_wq": _B_in["wq"],
        "B_wo": _B_in["wo"],
    }

def reference(A_x, A_k_cache, A_v_cache, A_wq, A_wo, B_x, B_k_cache, B_v_cache, B_wq, B_wo):
    def _A_ref(x, k_cache, v_cache, wq, wo):
        B, Sq, D = x.shape
        H, Dh = 32, 128
        q = (lambda x, *d: x.permute(*d))((x @ wq).reshape(B, Sq, H, Dh), 0, 2, 1, 3)
        scores = torch.einsum("bhqd,bhkd->bhqk", q, k_cache) * (Dh ** -0.5)
        p = _softmax(scores, axis=-1)
        o = torch.einsum("bhqk,bhkd->bhqd", p, v_cache)
        return (lambda x, *d: x.permute(*d))(o, 0, 2, 1, 3).reshape(B, Sq, H * Dh) @ wo

    def _B_ref(x, k_cache, v_cache, wq, wo):
        B, Sq, D = x.shape
        H, Dh = 32, 128
        q = (lambda x, *d: x.permute(*d))((x @ wq).reshape(B, Sq, H, Dh), 0, 2, 1, 3)
        scores = torch.einsum("bhqd,bhkd->bhqk", q, k_cache) * (Dh ** -0.5)
        p = _softmax(scores, axis=-1)
        o = torch.einsum("bhqk,bhkd->bhqd", p, v_cache)
        return (lambda x, *d: x.permute(*d))(o, 0, 2, 1, 3).reshape(B, Sq, H * Dh) @ wo

    a = _A_ref(A_x, A_k_cache, A_v_cache, A_wq, A_wo)
    b = _B_ref(B_x, B_k_cache, B_v_cache, B_wq, B_wo)
    return torch.concatenate([a, b], axis=-1)
```

```asm
; @launch kernel=attn_kernel grid=(512,1,1) block=(256,1,1) lds=81920
; @launch kernel=oproj_kernel grid=(256,1,1) block=(256,1,1) lds=98304
.amdgcn_target "amdgcn-amd-amdhsa--gfx950"
.text
.globl attn_kernel
.p2align 8
.type attn_kernel,@function
attn_kernel:
  s_cmp_ge_u32 s2, 512
  s_cbranch_scc1 K1_END
  s_and_b32 s33, s2, 7
  s_lshr_b32 s34, s2, 3
  s_and_b32 s35, s34, 3
  s_lshl_b32 s33, s33, 2
  s_add_u32 s35, s35, s33
  s_lshr_b32 s36, s34, 2
  s_and_b32 s36, s36, 7
  s_lshr_b32 s37, s34, 5
  s_mul_i32 s38, s37, 40
  s_add_u32 s40, s0, s38
  s_addc_u32 s41, s1, 0
  s_load_dwordx8 s[44:51], s[40:41], 0
  s_load_dwordx2 s[52:53], s[0:1], 96
  s_lshr_b32 s42, s2, 8
  s_mul_i32 s42, s42, 40
  s_add_u32 s42, s0, s42
  s_addc_u32 s43, s1, 0
  s_load_dwordx2 s[68:69], s[42:43], 32
  v_lshrrev_b32 v1, 6, v0
  v_and_b32 v2, 63, v0
  v_readfirstlane_b32 s24, v1
  v_lshrrev_b32 v3, 4, v2
  v_and_b32 v4, 15, v2
  v_lshlrev_b32 v252, 4, v2
  s_lshl_b32 s39, s24, 3
  v_add_u32 v5, s39, v3
  v_and_b32 v6, 15, v5
  v_xor_b32 v6, v6, v4
  v_lshlrev_b32 v6, 4, v6
  v_lshl_add_u32 v240, v5, 8, v6
  v_and_b32 v6, 7, v5
  v_lshlrev_b32 v6, 1, v6
  v_xor_b32 v6, v6, v4
  v_lshlrev_b32 v6, 4, v6
  v_lshl_add_u32 v242, v5, 8, v6
  v_add_u32 v5, s39, v3
  v_add_u32 v5, 4, v5
  v_and_b32 v6, 15, v5
  v_xor_b32 v6, v6, v4
  v_lshlrev_b32 v6, 4, v6
  v_lshl_add_u32 v241, v5, 8, v6
  v_and_b32 v6, 7, v5
  v_lshlrev_b32 v6, 1, v6
  v_xor_b32 v6, v6, v4
  v_lshlrev_b32 v6, 4, v6
  v_lshl_add_u32 v243, v5, 8, v6
  s_lshl_b32 s42, s24, 4
  v_add_u32 v5, s42, v3
  v_lshlrev_b32 v6, 1, v3
  v_xor_b32 v6, v6, v4
  v_lshlrev_b32 v6, 4, v6
  v_lshl_add_u32 v238, v5, 13, v6
  v_xor_b32 v239, 0x80, v238
  v_lshrrev_b32 v5, 2, v4
  v_lshl_add_u32 v6, v3, 3, v5
  v_lshlrev_b32 v6, 8, v6
  v_bfe_u32 v7, v4, 1, 1
  v_lshl_add_u32 v6, v7, 4, v6
  v_and_b32 v7, 1, v4
  v_lshl_add_u32 v6, v7, 3, v6
  v_and_b32 v7, 1, v3
  v_lshl_or_b32 v5, v7, 2, v5
  s_lshl_b32 s42, s24, 1
  s_add_u32 s33, s42, 0
  s_and_b32 s33, s33, 7
  v_xor_b32 v7, s33, v5
  v_lshl_add_u32 v228, v7, 5, v6
  s_add_u32 s33, s42, 1
  s_and_b32 s33, s33, 7
  v_xor_b32 v7, s33, v5
  v_lshl_add_u32 v229, v7, 5, v6
  s_add_u32 s33, s42, 2
  s_and_b32 s33, s33, 7
  v_xor_b32 v7, s33, v5
  v_lshl_add_u32 v230, v7, 5, v6
  s_add_u32 s33, s42, 3
  s_and_b32 s33, s33, 7
  v_xor_b32 v7, s33, v5
  v_lshl_add_u32 v231, v7, 5, v6
  s_add_u32 s33, s42, 4
  s_and_b32 s33, s33, 7
  v_xor_b32 v7, s33, v5
  v_lshl_add_u32 v232, v7, 5, v6
  s_add_u32 s33, s42, 5
  s_and_b32 s33, s33, 7
  v_xor_b32 v7, s33, v5
  v_lshl_add_u32 v233, v7, 5, v6
  s_add_u32 s33, s42, 6
  s_and_b32 s33, s33, 7
  v_xor_b32 v7, s33, v5
  v_lshl_add_u32 v234, v7, 5, v6
  s_add_u32 s33, s42, 7
  s_and_b32 s33, s33, 7
  v_xor_b32 v7, s33, v5
  v_lshl_add_u32 v235, v7, 5, v6
  s_add_u32 s33, s42, 0
  v_xor_b32 v7, s33, v5
  v_lshl_add_u32 v192, v7, 5, v6
  s_add_u32 s33, s42, 1
  v_xor_b32 v7, s33, v5
  v_lshl_add_u32 v193, v7, 5, v6
  v_lshrrev_b32 v5, 3, v2
  v_lshlrev_b32 v5, 10, v5
  s_and_b32 s42, s24, 1
  s_lshl_b32 s42, s42, 2
  v_add_u32 v6, s42, v3
  v_and_b32 v7, 7, v2
  v_xor_b32 v6, v6, v7
  v_lshl_add_u32 v236, v6, 4, v5
  v_lshrrev_b32 v5, 1, v4
  s_lshl_b32 s42, s24, 12
  s_add_u32 s42, s42, 0x8000
  v_add_u32 v6, 0, v3
  v_xor_b32 v6, v6, v5
  v_lshlrev_b32 v6, 4, v6
  v_lshl_add_u32 v6, v4, 7, v6
  v_add_u32 v96, s42, v6
  v_add_u32 v98, 0xc000, v6
  v_add_u32 v6, 4, v3
  v_xor_b32 v6, v6, v5
  v_lshlrev_b32 v6, 4, v6
  v_lshl_add_u32 v6, v4, 7, v6
  v_add_u32 v97, s42, v6
  v_add_u32 v99, 0xc000, v6
  s_lshl_b32 s27, s24, 11
  s_mov_b32 s25, 0
  s_waitcnt lgkmcnt(0)
  s_lshl_b32 s42, s36, 5
  s_add_u32 s42, s42, s35
  s_lshl_b32 s42, s42, 18
  s_add_u32 s4, s46, s42
  s_addc_u32 s5, s47, 0
  s_mov_b32 s6, 262144
  s_mov_b32 s7, 0x00020000
  s_add_u32 s8, s48, s42
  s_addc_u32 s9, s49, 0
  s_mov_b32 s10, 262144
  s_mov_b32 s11, 0x00020000
  s_lshl_b32 s42, s35, 8
  s_add_u32 s12, s50, s42
  s_addc_u32 s13, s51, 0
  s_sub_u32 s14, 0x400000, s42
  s_mov_b32 s15, 0x00020000
  s_mul_i32 s42, s36, 147456
  s_add_u32 s16, s44, s42
  s_addc_u32 s17, s45, 0
  s_mov_b32 s18, 147456
  s_mov_b32 s19, 0x00020000
  s_lshl_b32 s42, s37, 3
  s_add_u32 s42, s42, s36
  s_mul_i32 s42, s42, 288
  s_add_u32 s42, s42, s35
  s_lshl_b32 s42, s42, 12
  s_add_u32 s20, s52, s42
  s_addc_u32 s21, s53, 0
  s_mov_b32 s22, 1052672
  s_mov_b32 s23, 0x00020000
  s_and_b32 s42, s2, 255
  s_lshl_b32 s42, s42, 14
  s_add_u32 s68, s68, s42
  s_addc_u32 s69, s69, 0
  s_mov_b32 s70, 16384
  s_mov_b32 s71, 0x00020000
  s_lshl_b32 s43, s24, 12
  s_and_b32 s33, s35, 3
  s_lshl_b32 s33, s33, 1
  s_add_u32 s33, s33, s36
  s_and_b32 s54, s33, 7
  s_lshl_b32 s53, s24, 13
  s_lshl_b32 s32, s24, 10
  s_add_u32 s55, s54, 0
  s_and_b32 s55, s55, 7
  s_lshl_b32 s33, s55, 7
  s_lshl_b32 s55, s55, 19
  s_add_u32 s33, s33, s53
  s_add_u32 m0, s43, 0x0
  s_add_u32 s52, s55, 0x0
  buffer_load_dwordx4 v238, s[12:15], s52 offen lds
  s_add_u32 m0, s43, 0x400
  s_add_u32 s52, s55, 0x8000
  buffer_load_dwordx4 v238, s[12:15], s52 offen lds
  s_add_u32 m0, s43, 0x800
  s_add_u32 s52, s55, 0x10000
  buffer_load_dwordx4 v239, s[12:15], s52 offen lds
  s_add_u32 m0, s43, 0xc00
  s_add_u32 s52, s55, 0x18000
  buffer_load_dwordx4 v239, s[12:15], s52 offen lds
  s_add_u32 m0, s32, 0x8000
  s_add_u32 s52, s33, 0x0
  buffer_load_dwordx4 v236, s[16:19], s52 offen lds
  s_add_u32 m0, s32, 0x9000
  s_add_u32 s52, s33, 0x8000
  buffer_load_dwordx4 v236, s[16:19], s52 offen lds
  s_add_u32 m0, s32, 0xa000
  s_add_u32 s52, s33, 0x10000
  buffer_load_dwordx4 v236, s[16:19], s52 offen lds
  s_add_u32 m0, s32, 0xb000
  s_add_u32 s52, s33, 0x18000
  buffer_load_dwordx4 v236, s[16:19], s52 offen lds
  s_add_u32 m0, s32, 0xc000
  s_add_u32 s52, s33, 0x20000
  buffer_load_dwordx4 v236, s[16:19], s52 offen lds
  s_waitcnt vmcnt(0)
  s_barrier
  s_add_u32 s55, s54, 1
  s_and_b32 s55, s55, 7
  s_lshl_b32 s33, s55, 7
  s_lshl_b32 s55, s55, 19
  s_add_u32 s33, s33, s53
  s_add_u32 m0, s43, 0x4000
  s_add_u32 s52, s55, 0x0
  buffer_load_dwordx4 v238, s[12:15], s52 offen lds
  s_add_u32 m0, s43, 0x4400
  s_add_u32 s52, s55, 0x8000
  buffer_load_dwordx4 v238, s[12:15], s52 offen lds
  s_add_u32 m0, s43, 0x4800
  s_add_u32 s52, s55, 0x10000
  buffer_load_dwordx4 v239, s[12:15], s52 offen lds
  s_add_u32 m0, s43, 0x4c00
  s_add_u32 s52, s55, 0x18000
  buffer_load_dwordx4 v239, s[12:15], s52 offen lds
  s_add_u32 m0, s32, 0xd000
  s_add_u32 s52, s33, 0x0
  buffer_load_dwordx4 v236, s[16:19], s52 offen lds
  s_add_u32 m0, s32, 0xe000
  s_add_u32 s52, s33, 0x8000
  buffer_load_dwordx4 v236, s[16:19], s52 offen lds
  s_add_u32 m0, s32, 0xf000
  s_add_u32 s52, s33, 0x10000
  buffer_load_dwordx4 v236, s[16:19], s52 offen lds
  s_add_u32 m0, s32, 0x10000
  s_add_u32 s52, s33, 0x18000
  buffer_load_dwordx4 v236, s[16:19], s52 offen lds
  s_add_u32 m0, s32, 0x11000
  s_add_u32 s52, s33, 0x20000
  buffer_load_dwordx4 v236, s[16:19], s52 offen lds
  ds_read_b128 v[72:75], v96 offset:0
  ds_read_b128 v[76:79], v96 offset:2048
  ds_read_b128 v[80:83], v98 offset:0
  ds_read_b64_tr_b16 v[196:197], v228 offset:0
  ds_read_b64_tr_b16 v[198:199], v228 offset:1024
  ds_read_b64_tr_b16 v[200:201], v229 offset:0
  ds_read_b64_tr_b16 v[202:203], v229 offset:1024
  ds_read_b64_tr_b16 v[204:205], v230 offset:0
  ds_read_b64_tr_b16 v[206:207], v230 offset:1024
  ds_read_b64_tr_b16 v[208:209], v231 offset:0
  ds_read_b64_tr_b16 v[210:211], v231 offset:1024
  ds_read_b64_tr_b16 v[212:213], v232 offset:0
  ds_read_b64_tr_b16 v[214:215], v232 offset:1024
  ds_read_b64_tr_b16 v[216:217], v233 offset:0
  ds_read_b64_tr_b16 v[218:219], v233 offset:1024
  ds_read_b64_tr_b16 v[220:221], v234 offset:0
  ds_read_b64_tr_b16 v[222:223], v234 offset:1024
  ds_read_b64_tr_b16 v[224:225], v235 offset:0
  ds_read_b64_tr_b16 v[226:227], v235 offset:1024
  s_waitcnt lgkmcnt(8)
  v_mfma_f32_16x16x32_bf16 v[0:3], v[196:199], v[72:75], 0
  v_mfma_f32_16x16x32_bf16 v[32:35], v[196:199], v[76:79], 0
  v_mfma_f32_16x16x32_bf16 v[4:7], v[200:203], v[72:75], 0
  v_mfma_f32_16x16x32_bf16 v[36:39], v[200:203], v[76:79], 0
  v_mfma_f32_16x16x32_bf16 v[8:11], v[204:207], v[72:75], 0
  v_mfma_f32_16x16x32_bf16 v[40:43], v[204:207], v[76:79], 0
  v_mfma_f32_16x16x32_bf16 v[12:15], v[208:211], v[72:75], 0
  v_mfma_f32_16x16x32_bf16 v[44:47], v[208:211], v[76:79], 0
  v_mfma_f32_16x16x32_bf16 v[64:67], v[196:199], v[80:83], 0
  v_mfma_f32_16x16x32_bf16 v[68:71], v[200:203], v[80:83], 0
  ds_read_b128 v[84:87], v97 offset:0
  ds_read_b128 v[88:91], v97 offset:2048
  ds_read_b128 v[92:95], v99 offset:0
  ds_read_b64_tr_b16 v[196:197], v228 offset:8192
  ds_read_b64_tr_b16 v[198:199], v228 offset:9216
  ds_read_b64_tr_b16 v[200:201], v229 offset:8192
  ds_read_b64_tr_b16 v[202:203], v229 offset:9216
  ds_read_b64_tr_b16 v[204:205], v230 offset:8192
  ds_read_b64_tr_b16 v[206:207], v230 offset:9216
  ds_read_b64_tr_b16 v[208:209], v231 offset:8192
  ds_read_b64_tr_b16 v[210:211], v231 offset:9216
  s_waitcnt lgkmcnt(11)
  v_mfma_f32_16x16x32_bf16 v[16:19], v[212:215], v[72:75], 0
  v_mfma_f32_16x16x32_bf16 v[48:51], v[212:215], v[76:79], 0
  v_mfma_f32_16x16x32_bf16 v[20:23], v[216:219], v[72:75], 0
  v_mfma_f32_16x16x32_bf16 v[52:55], v[216:219], v[76:79], 0
  v_mfma_f32_16x16x32_bf16 v[24:27], v[220:223], v[72:75], 0
  v_mfma_f32_16x16x32_bf16 v[56:59], v[220:223], v[76:79], 0
  v_mfma_f32_16x16x32_bf16 v[28:31], v[224:227], v[72:75], 0
  v_mfma_f32_16x16x32_bf16 v[60:63], v[224:227], v[76:79], 0
  ds_read_b64_tr_b16 v[212:213], v232 offset:8192
  ds_read_b64_tr_b16 v[214:215], v232 offset:9216
  ds_read_b64_tr_b16 v[216:217], v233 offset:8192
  ds_read_b64_tr_b16 v[218:219], v233 offset:9216
  ds_read_b64_tr_b16 v[220:221], v234 offset:8192
  ds_read_b64_tr_b16 v[222:223], v234 offset:9216
  ds_read_b64_tr_b16 v[224:225], v235 offset:8192
  ds_read_b64_tr_b16 v[226:227], v235 offset:9216
  s_waitcnt lgkmcnt(8)
  v_mfma_f32_16x16x32_bf16 v[0:3], v[196:199], v[84:87], v[0:3]
  v_mfma_f32_16x16x32_bf16 v[32:35], v[196:199], v[88:91], v[32:35]
  v_mfma_f32_16x16x32_bf16 v[4:7], v[200:203], v[84:87], v[4:7]
  v_mfma_f32_16x16x32_bf16 v[36:39], v[200:203], v[88:91], v[36:39]
  v_mfma_f32_16x16x32_bf16 v[8:11], v[204:207], v[84:87], v[8:11]
  v_mfma_f32_16x16x32_bf16 v[40:43], v[204:207], v[88:91], v[40:43]
  v_mfma_f32_16x16x32_bf16 v[12:15], v[208:211], v[84:87], v[12:15]
  v_mfma_f32_16x16x32_bf16 v[44:47], v[208:211], v[88:91], v[44:47]
  v_mfma_f32_16x16x32_bf16 v[64:67], v[196:199], v[92:95], v[64:67]
  v_mfma_f32_16x16x32_bf16 v[68:71], v[200:203], v[92:95], v[68:71]
  s_waitcnt vmcnt(0) lgkmcnt(0)
  s_barrier
  ds_read_b128 v[72:75], v96 offset:20480
  ds_read_b128 v[76:79], v96 offset:22528
  ds_read_b128 v[80:83], v98 offset:20480
  ds_read_b64_tr_b16 v[196:197], v228 offset:16384
  ds_read_b64_tr_b16 v[198:199], v228 offset:17408
  ds_read_b64_tr_b16 v[200:201], v229 offset:16384
  ds_read_b64_tr_b16 v[202:203], v229 offset:17408
  ds_read_b64_tr_b16 v[204:205], v230 offset:16384
  ds_read_b64_tr_b16 v[206:207], v230 offset:17408
  ds_read_b64_tr_b16 v[208:209], v231 offset:16384
  ds_read_b64_tr_b16 v[210:211], v231 offset:17408
  s_add_u32 s55, s54, 2
  s_and_b32 s55, s55, 7
  s_lshl_b32 s33, s55, 7
  s_lshl_b32 s55, s55, 19
  s_add_u32 s33, s33, s53
  s_add_u32 m0, s43, 0x0
  s_add_u32 s52, s55, 0x0
  buffer_load_dwordx4 v238, s[12:15], s52 offen lds
  s_add_u32 m0, s43, 0x400
  s_add_u32 s52, s55, 0x8000
  buffer_load_dwordx4 v238, s[12:15], s52 offen lds
  s_add_u32 m0, s43, 0x800
  s_add_u32 s52, s55, 0x10000
  buffer_load_dwordx4 v239, s[12:15], s52 offen lds
  s_add_u32 m0, s43, 0xc00
  s_add_u32 s52, s55, 0x18000
  buffer_load_dwordx4 v239, s[12:15], s52 offen lds
  s_add_u32 m0, s32, 0x8000
  s_add_u32 s52, s33, 0x0
  buffer_load_dwordx4 v236, s[16:19], s52 offen lds
  s_add_u32 m0, s32, 0x9000
  s_add_u32 s52, s33, 0x8000
  buffer_load_dwordx4 v236, s[16:19], s52 offen lds
  s_add_u32 m0, s32, 0xa000
  s_add_u32 s52, s33, 0x10000
  buffer_load_dwordx4 v236, s[16:19], s52 offen lds
  s_add_u32 m0, s32, 0xb000
  s_add_u32 s52, s33, 0x18000
  buffer_load_dwordx4 v236, s[16:19], s52 offen lds
  s_add_u32 m0, s32, 0xc000
  s_add_u32 s52, s33, 0x20000
  buffer_load_dwordx4 v236, s[16:19], s52 offen lds
  v_mfma_f32_16x16x32_bf16 v[16:19], v[212:215], v[84:87], v[16:19]
  v_mfma_f32_16x16x32_bf16 v[48:51], v[212:215], v[88:91], v[48:51]
  v_mfma_f32_16x16x32_bf16 v[20:23], v[216:219], v[84:87], v[20:23]
  v_mfma_f32_16x16x32_bf16 v[52:55], v[216:219], v[88:91], v[52:55]
  v_mfma_f32_16x16x32_bf16 v[24:27], v[220:223], v[84:87], v[24:27]
  v_mfma_f32_16x16x32_bf16 v[56:59], v[220:223], v[88:91], v[56:59]
  v_mfma_f32_16x16x32_bf16 v[28:31], v[224:227], v[84:87], v[28:31]
  v_mfma_f32_16x16x32_bf16 v[60:63], v[224:227], v[88:91], v[60:63]
  ds_read_b64_tr_b16 v[212:213], v232 offset:16384
  ds_read_b64_tr_b16 v[214:215], v232 offset:17408
  ds_read_b64_tr_b16 v[216:217], v233 offset:16384
  ds_read_b64_tr_b16 v[218:219], v233 offset:17408
  ds_read_b64_tr_b16 v[220:221], v234 offset:16384
  ds_read_b64_tr_b16 v[222:223], v234 offset:17408
  ds_read_b64_tr_b16 v[224:225], v235 offset:16384
  ds_read_b64_tr_b16 v[226:227], v235 offset:17408
  s_waitcnt lgkmcnt(8)
  v_mfma_f32_16x16x32_bf16 v[0:3], v[196:199], v[72:75], v[0:3]
  v_mfma_f32_16x16x32_bf16 v[32:35], v[196:199], v[76:79], v[32:35]
  v_mfma_f32_16x16x32_bf16 v[4:7], v[200:203], v[72:75], v[4:7]
  v_mfma_f32_16x16x32_bf16 v[36:39], v[200:203], v[76:79], v[36:39]
  v_mfma_f32_16x16x32_bf16 v[8:11], v[204:207], v[72:75], v[8:11]
  v_mfma_f32_16x16x32_bf16 v[40:43], v[204:207], v[76:79], v[40:43]
  v_mfma_f32_16x16x32_bf16 v[12:15], v[208:211], v[72:75], v[12:15]
  v_mfma_f32_16x16x32_bf16 v[44:47], v[208:211], v[76:79], v[44:47]
  v_mfma_f32_16x16x32_bf16 v[64:67], v[196:199], v[80:83], v[64:67]
  v_mfma_f32_16x16x32_bf16 v[68:71], v[200:203], v[80:83], v[68:71]
  ds_read_b128 v[84:87], v97 offset:20480
  ds_read_b128 v[88:91], v97 offset:22528
  ds_read_b128 v[92:95], v99 offset:20480
  ds_read_b64_tr_b16 v[196:197], v228 offset:24576
  ds_read_b64_tr_b16 v[198:199], v228 offset:25600
  ds_read_b64_tr_b16 v[200:201], v229 offset:24576
  ds_read_b64_tr_b16 v[202:203], v229 offset:25600
  ds_read_b64_tr_b16 v[204:205], v230 offset:24576
  ds_read_b64_tr_b16 v[206:207], v230 offset:25600
  ds_read_b64_tr_b16 v[208:209], v231 offset:24576
  ds_read_b64_tr_b16 v[210:211], v231 offset:25600
  s_waitcnt lgkmcnt(11)
  v_mfma_f32_16x16x32_bf16 v[16:19], v[212:215], v[72:75], v[16:19]
  v_mfma_f32_16x16x32_bf16 v[48:51], v[212:215], v[76:79], v[48:51]
  v_mfma_f32_16x16x32_bf16 v[20:23], v[216:219], v[72:75], v[20:23]
  v_mfma_f32_16x16x32_bf16 v[52:55], v[216:219], v[76:79], v[52:55]
  v_mfma_f32_16x16x32_bf16 v[24:27], v[220:223], v[72:75], v[24:27]
  v_mfma_f32_16x16x32_bf16 v[56:59], v[220:223], v[76:79], v[56:59]
  v_mfma_f32_16x16x32_bf16 v[28:31], v[224:227], v[72:75], v[28:31]
  v_mfma_f32_16x16x32_bf16 v[60:63], v[224:227], v[76:79], v[60:63]
  ds_read_b64_tr_b16 v[212:213], v232 offset:24576
  ds_read_b64_tr_b16 v[214:215], v232 offset:25600
  ds_read_b64_tr_b16 v[216:217], v233 offset:24576
  ds_read_b64_tr_b16 v[218:219], v233 offset:25600
  ds_read_b64_tr_b16 v[220:221], v234 offset:24576
  ds_read_b64_tr_b16 v[222:223], v234 offset:25600
  ds_read_b64_tr_b16 v[224:225], v235 offset:24576
  ds_read_b64_tr_b16 v[226:227], v235 offset:25600
  s_waitcnt lgkmcnt(8)
  v_mfma_f32_16x16x32_bf16 v[0:3], v[196:199], v[84:87], v[0:3]
  v_mfma_f32_16x16x32_bf16 v[32:35], v[196:199], v[88:91], v[32:35]
  v_mfma_f32_16x16x32_bf16 v[4:7], v[200:203], v[84:87], v[4:7]
  v_mfma_f32_16x16x32_bf16 v[36:39], v[200:203], v[88:91], v[36:39]
  v_mfma_f32_16x16x32_bf16 v[8:11], v[204:207], v[84:87], v[8:11]
  v_mfma_f32_16x16x32_bf16 v[40:43], v[204:207], v[88:91], v[40:43]
  v_mfma_f32_16x16x32_bf16 v[12:15], v[208:211], v[84:87], v[12:15]
  v_mfma_f32_16x16x32_bf16 v[44:47], v[208:211], v[88:91], v[44:47]
  v_mfma_f32_16x16x32_bf16 v[64:67], v[196:199], v[92:95], v[64:67]
  v_mfma_f32_16x16x32_bf16 v[68:71], v[200:203], v[92:95], v[68:71]
  s_waitcnt vmcnt(0) lgkmcnt(0)
  s_barrier
  ds_read_b128 v[72:75], v96 offset:0
  ds_read_b128 v[76:79], v96 offset:2048
  ds_read_b128 v[80:83], v98 offset:0
  ds_read_b64_tr_b16 v[196:197], v228 offset:0
  ds_read_b64_tr_b16 v[198:199], v228 offset:1024
  ds_read_b64_tr_b16 v[200:201], v229 offset:0
  ds_read_b64_tr_b16 v[202:203], v229 offset:1024
  ds_read_b64_tr_b16 v[204:205], v230 offset:0
  ds_read_b64_tr_b16 v[206:207], v230 offset:1024
  ds_read_b64_tr_b16 v[208:209], v231 offset:0
  ds_read_b64_tr_b16 v[210:211], v231 offset:1024
  s_add_u32 s55, s54, 3
  s_and_b32 s55, s55, 7
  s_lshl_b32 s33, s55, 7
  s_lshl_b32 s55, s55, 19
  s_add_u32 s33, s33, s53
  s_add_u32 m0, s43, 0x4000
  s_add_u32 s52, s55, 0x0
  buffer_load_dwordx4 v238, s[12:15], s52 offen lds
  s_add_u32 m0, s43, 0x4400
  s_add_u32 s52, s55, 0x8000
  buffer_load_dwordx4 v238, s[12:15], s52 offen lds
  s_add_u32 m0, s43, 0x4800
  s_add_u32 s52, s55, 0x10000
  buffer_load_dwordx4 v239, s[12:15], s52 offen lds
  s_add_u32 m0, s43, 0x4c00
  s_add_u32 s52, s55, 0x18000
  buffer_load_dwordx4 v239, s[12:15], s52 offen lds
  s_add_u32 m0, s32, 0xd000
  s_add_u32 s52, s33, 0x0
  buffer_load_dwordx4 v236, s[16:19], s52 offen lds
  s_add_u32 m0, s32, 0xe000
  s_add_u32 s52, s33, 0x8000
  buffer_load_dwordx4 v236, s[16:19], s52 offen lds
  s_add_u32 m0, s32, 0xf000
  s_add_u32 s52, s33, 0x10000
  buffer_load_dwordx4 v236, s[16:19], s52 offen lds
  s_add_u32 m0, s32, 0x10000
  s_add_u32 s52, s33, 0x18000
  buffer_load_dwordx4 v236, s[16:19], s52 offen lds
  s_add_u32 m0, s32, 0x11000
  s_add_u32 s52, s33, 0x20000
  buffer_load_dwordx4 v236, s[16:19], s52 offen lds
  v_mfma_f32_16x16x32_bf16 v[16:19], v[212:215], v[84:87], v[16:19]
  v_mfma_f32_16x16x32_bf16 v[48:51], v[212:215], v[88:91], v[48:51]
  v_mfma_f32_16x16x32_bf16 v[20:23], v[216:219], v[84:87], v[20:23]
  v_mfma_f32_16x16x32_bf16 v[52:55], v[216:219], v[88:91], v[52:55]
  v_mfma_f32_16x16x32_bf16 v[24:27], v[220:223], v[84:87], v[24:27]
  v_mfma_f32_16x16x32_bf16 v[56:59], v[220:223], v[88:91], v[56:59]
  v_mfma_f32_16x16x32_bf16 v[28:31], v[224:227], v[84:87], v[28:31]
  v_mfma_f32_16x16x32_bf16 v[60:63], v[224:227], v[88:91], v[60:63]
  ds_read_b64_tr_b16 v[212:213], v232 offset:0
  ds_read_b64_tr_b16 v[214:215], v232 offset:1024
  ds_read_b64_tr_b16 v[216:217], v233 offset:0
  ds_read_b64_tr_b16 v[218:219], v233 offset:1024
  ds_read_b64_tr_b16 v[220:221], v234 offset:0
  ds_read_b64_tr_b16 v[222:223], v234 offset:1024
  ds_read_b64_tr_b16 v[224:225], v235 offset:0
  ds_read_b64_tr_b16 v[226:227], v235 offset:1024
  s_waitcnt lgkmcnt(8)
  v_mfma_f32_16x16x32_bf16 v[0:3], v[196:199], v[72:75], v[0:3]
  v_mfma_f32_16x16x32_bf16 v[32:35], v[196:199], v[76:79], v[32:35]
  v_mfma_f32_16x16x32_bf16 v[4:7], v[200:203], v[72:75], v[4:7]
  v_mfma_f32_16x16x32_bf16 v[36:39], v[200:203], v[76:79], v[36:39]
  v_mfma_f32_16x16x32_bf16 v[8:11], v[204:207], v[72:75], v[8:11]
  v_mfma_f32_16x16x32_bf16 v[40:43], v[204:207], v[76:79], v[40:43]
  v_mfma_f32_16x16x32_bf16 v[12:15], v[208:211], v[72:75], v[12:15]
  v_mfma_f32_16x16x32_bf16 v[44:47], v[208:211], v[76:79], v[44:47]
  v_mfma_f32_16x16x32_bf16 v[64:67], v[196:199], v[80:83], v[64:67]
  v_mfma_f32_16x16x32_bf16 v[68:71], v[200:203], v[80:83], v[68:71]
  ds_read_b128 v[84:87], v97 offset:0
  ds_read_b128 v[88:91], v97 offset:2048
  ds_read_b128 v[92:95], v99 offset:0
  ds_read_b64_tr_b16 v[196:197], v228 offset:8192
  ds_read_b64_tr_b16 v[198:199], v228 offset:9216
  ds_read_b64_tr_b16 v[200:201], v229 offset:8192
  ds_read_b64_tr_b16 v[202:203], v229 offset:9216
  ds_read_b64_tr_b16 v[204:205], v230 offset:8192
  ds_read_b64_tr_b16 v[206:207], v230 offset:9216
  ds_read_b64_tr_b16 v[208:209], v231 offset:8192
  ds_read_b64_tr_b16 v[210:211], v231 offset:9216
  s_waitcnt lgkmcnt(11)
  v_mfma_f32_16x16x32_bf16 v[16:19], v[212:215], v[72:75], v[16:19]
  v_mfma_f32_16x16x32_bf16 v[48:51], v[212:215], v[76:79], v[48:51]
  v_mfma_f32_16x16x32_bf16 v[20:23], v[216:219], v[72:75], v[20:23]
  v_mfma_f32_16x16x32_bf16 v[52:55], v[216:219], v[76:79], v[52:55]
  v_mfma_f32_16x16x32_bf16 v[24:27], v[220:223], v[72:75], v[24:27]
  v_mfma_f32_16x16x32_bf16 v[56:59], v[220:223], v[76:79], v[56:59]
  v_mfma_f32_16x16x32_bf16 v[28:31], v[224:227], v[72:75], v[28:31]
  v_mfma_f32_16x16x32_bf16 v[60:63], v[224:227], v[76:79], v[60:63]
  ds_read_b64_tr_b16 v[212:213], v232 offset:8192
  ds_read_b64_tr_b16 v[214:215], v232 offset:9216
  ds_read_b64_tr_b16 v[216:217], v233 offset:8192
  ds_read_b64_tr_b16 v[218:219], v233 offset:9216
  ds_read_b64_tr_b16 v[220:221], v234 offset:8192
  ds_read_b64_tr_b16 v[222:223], v234 offset:9216
  ds_read_b64_tr_b16 v[224:225], v235 offset:8192
  ds_read_b64_tr_b16 v[226:227], v235 offset:9216
  s_waitcnt lgkmcnt(8)
  v_mfma_f32_16x16x32_bf16 v[0:3], v[196:199], v[84:87], v[0:3]
  v_mfma_f32_16x16x32_bf16 v[32:35], v[196:199], v[88:91], v[32:35]
  v_mfma_f32_16x16x32_bf16 v[4:7], v[200:203], v[84:87], v[4:7]
  v_mfma_f32_16x16x32_bf16 v[36:39], v[200:203], v[88:91], v[36:39]
  v_mfma_f32_16x16x32_bf16 v[8:11], v[204:207], v[84:87], v[8:11]
  v_mfma_f32_16x16x32_bf16 v[40:43], v[204:207], v[88:91], v[40:43]
  v_mfma_f32_16x16x32_bf16 v[12:15], v[208:211], v[84:87], v[12:15]
  v_mfma_f32_16x16x32_bf16 v[44:47], v[208:211], v[88:91], v[44:47]
  v_mfma_f32_16x16x32_bf16 v[64:67], v[196:199], v[92:95], v[64:67]
  v_mfma_f32_16x16x32_bf16 v[68:71], v[200:203], v[92:95], v[68:71]
  s_waitcnt vmcnt(0) lgkmcnt(0)
  s_barrier
  ds_read_b128 v[72:75], v96 offset:20480
  ds_read_b128 v[76:79], v96 offset:22528
  ds_read_b128 v[80:83], v98 offset:20480
  ds_read_b64_tr_b16 v[196:197], v228 offset:16384
  ds_read_b64_tr_b16 v[198:199], v228 offset:17408
  ds_read_b64_tr_b16 v[200:201], v229 offset:16384
  ds_read_b64_tr_b16 v[202:203], v229 offset:17408
  ds_read_b64_tr_b16 v[204:205], v230 offset:16384
  ds_read_b64_tr_b16 v[206:207], v230 offset:17408
  ds_read_b64_tr_b16 v[208:209], v231 offset:16384
  ds_read_b64_tr_b16 v[210:211], v231 offset:17408
  s_add_u32 s55, s54, 4
  s_and_b32 s55, s55, 7
  s_lshl_b32 s33, s55, 7
  s_lshl_b32 s55, s55, 19
  s_add_u32 s33, s33, s53
  s_add_u32 m0, s43, 0x0
  s_add_u32 s52, s55, 0x0
  buffer_load_dwordx4 v238, s[12:15], s52 offen lds
  s_add_u32 m0, s43, 0x400
  s_add_u32 s52, s55, 0x8000
  buffer_load_dwordx4 v238, s[12:15], s52 offen lds
  s_add_u32 m0, s43, 0x800
  s_add_u32 s52, s55, 0x10000
  buffer_load_dwordx4 v239, s[12:15], s52 offen lds
  s_add_u32 m0, s43, 0xc00
  s_add_u32 s52, s55, 0x18000
  buffer_load_dwordx4 v239, s[12:15], s52 offen lds
  s_add_u32 m0, s32, 0x8000
  s_add_u32 s52, s33, 0x0
  buffer_load_dwordx4 v236, s[16:19], s52 offen lds
  s_add_u32 m0, s32, 0x9000
  s_add_u32 s52, s33, 0x8000
  buffer_load_dwordx4 v236, s[16:19], s52 offen lds
  s_add_u32 m0, s32, 0xa000
  s_add_u32 s52, s33, 0x10000
  buffer_load_dwordx4 v236, s[16:19], s52 offen lds
  s_add_u32 m0, s32, 0xb000
  s_add_u32 s52, s33, 0x18000
  buffer_load_dwordx4 v236, s[16:19], s52 offen lds
  s_add_u32 m0, s32, 0xc000
  s_add_u32 s52, s33, 0x20000
  buffer_load_dwordx4 v236, s[16:19], s52 offen lds
  v_mfma_f32_16x16x32_bf16 v[16:19], v[212:215], v[84:87], v[16:19]
  v_mfma_f32_16x16x32_bf16 v[48:51], v[212:215], v[88:91], v[48:51]
  v_mfma_f32_16x16x32_bf16 v[20:23], v[216:219], v[84:87], v[20:23]
  v_mfma_f32_16x16x32_bf16 v[52:55], v[216:219], v[88:91], v[52:55]
  v_mfma_f32_16x16x32_bf16 v[24:27], v[220:223], v[84:87], v[24:27]
  v_mfma_f32_16x16x32_bf16 v[56:59], v[220:223], v[88:91], v[56:59]
  v_mfma_f32_16x16x32_bf16 v[28:31], v[224:227], v[84:87], v[28:31]
  v_mfma_f32_16x16x32_bf16 v[60:63], v[224:227], v[88:91], v[60:63]
  ds_read_b64_tr_b16 v[212:213], v232 offset:16384
  ds_read_b64_tr_b16 v[214:215], v232 offset:17408
  ds_read_b64_tr_b16 v[216:217], v233 offset:16384
  ds_read_b64_tr_b16 v[218:219], v233 offset:17408
  ds_read_b64_tr_b16 v[220:221], v234 offset:16384
  ds_read_b64_tr_b16 v[222:223], v234 offset:17408
  ds_read_b64_tr_b16 v[224:225], v235 offset:16384
  ds_read_b64_tr_b16 v[226:227], v235 offset:17408
  s_waitcnt lgkmcnt(8)
  v_mfma_f32_16x16x32_bf16 v[0:3], v[196:199], v[72:75], v[0:3]
  v_mfma_f32_16x16x32_bf16 v[32:35], v[196:199], v[76:79], v[32:35]
  v_mfma_f32_16x16x32_bf16 v[4:7], v[200:203], v[72:75], v[4:7]
  v_mfma_f32_16x16x32_bf16 v[36:39], v[200:203], v[76:79], v[36:39]
  v_mfma_f32_16x16x32_bf16 v[8:11], v[204:207], v[72:75], v[8:11]
  v_mfma_f32_16x16x32_bf16 v[40:43], v[204:207], v[76:79], v[40:43]
  v_mfma_f32_16x16x32_bf16 v[12:15], v[208:211], v[72:75], v[12:15]
  v_mfma_f32_16x16x32_bf16 v[44:47], v[208:211], v[76:79], v[44:47]
  v_mfma_f32_16x16x32_bf16 v[64:67], v[196:199], v[80:83], v[64:67]
  v_mfma_f32_16x16x32_bf16 v[68:71], v[200:203], v[80:83], v[68:71]
  ds_read_b128 v[84:87], v97 offset:20480
  ds_read_b128 v[88:91], v97 offset:22528
  ds_read_b128 v[92:95], v99 offset:20480
  ds_read_b64_tr_b16 v[196:197], v228 offset:24576
  ds_read_b64_tr_b16 v[198:199], v228 offset:25600
  ds_read_b64_tr_b16 v[200:201], v229 offset:24576
  ds_read_b64_tr_b16 v[202:203], v229 offset:25600
  ds_read_b64_tr_b16 v[204:205], v230 offset:24576
  ds_read_b64_tr_b16 v[206:207], v230 offset:25600
  ds_read_b64_tr_b16 v[208:209], v231 offset:24576
  ds_read_b64_tr_b16 v[210:211], v231 offset:25600
  s_waitcnt lgkmcnt(11)
  v_mfma_f32_16x16x32_bf16 v[16:19], v[212:215], v[72:75], v[16:19]
  v_mfma_f32_16x16x32_bf16 v[48:51], v[212:215], v[76:79], v[48:51]
  v_mfma_f32_16x16x32_bf16 v[20:23], v[216:219], v[72:75], v[20:23]
  v_mfma_f32_16x16x32_bf16 v[52:55], v[216:219], v[76:79], v[52:55]
  v_mfma_f32_16x16x32_bf16 v[24:27], v[220:223], v[72:75], v[24:27]
  v_mfma_f32_16x16x32_bf16 v[56:59], v[220:223], v[76:79], v[56:59]
  v_mfma_f32_16x16x32_bf16 v[28:31], v[224:227], v[72:75], v[28:31]
  v_mfma_f32_16x16x32_bf16 v[60:63], v[224:227], v[76:79], v[60:63]
  ds_read_b64_tr_b16 v[212:213], v232 offset:24576
  ds_read_b64_tr_b16 v[214:215], v232 offset:25600
  ds_read_b64_tr_b16 v[216:217], v233 offset:24576
  ds_read_b64_tr_b16 v[218:219], v233 offset:25600
  ds_read_b64_tr_b16 v[220:221], v234 offset:24576
  ds_read_b64_tr_b16 v[222:223], v234 offset:25600
  ds_read_b64_tr_b16 v[224:225], v235 offset:24576
  ds_read_b64_tr_b16 v[226:227], v235 offset:25600
  s_waitcnt lgkmcnt(8)
  v_mfma_f32_16x16x32_bf16 v[0:3], v[196:199], v[84:87], v[0:3]
  v_mfma_f32_16x16x32_bf16 v[32:35], v[196:199], v[88:91], v[32:35]
  v_mfma_f32_16x16x32_bf16 v[4:7], v[200:203], v[84:87], v[4:7]
  v_mfma_f32_16x16x32_bf16 v[36:39], v[200:203], v[88:91], v[36:39]
  v_mfma_f32_16x16x32_bf16 v[8:11], v[204:207], v[84:87], v[8:11]
  v_mfma_f32_16x16x32_bf16 v[40:43], v[204:207], v[88:91], v[40:43]
  v_mfma_f32_16x16x32_bf16 v[12:15], v[208:211], v[84:87], v[12:15]
  v_mfma_f32_16x16x32_bf16 v[44:47], v[208:211], v[88:91], v[44:47]
  v_mfma_f32_16x16x32_bf16 v[64:67], v[196:199], v[92:95], v[64:67]
  v_mfma_f32_16x16x32_bf16 v[68:71], v[200:203], v[92:95], v[68:71]
  s_waitcnt vmcnt(0) lgkmcnt(0)
  s_barrier
  ds_read_b128 v[72:75], v96 offset:0
  ds_read_b128 v[76:79], v96 offset:2048
  ds_read_b128 v[80:83], v98 offset:0
  ds_read_b64_tr_b16 v[196:197], v228 offset:0
  ds_read_b64_tr_b16 v[198:199], v228 offset:1024
  ds_read_b64_tr_b16 v[200:201], v229 offset:0
  ds_read_b64_tr_b16 v[202:203], v229 offset:1024
  ds_read_b64_tr_b16 v[204:205], v230 offset:0
  ds_read_b64_tr_b16 v[206:207], v230 offset:1024
  ds_read_b64_tr_b16 v[208:209], v231 offset:0
  ds_read_b64_tr_b16 v[210:211], v231 offset:1024
  s_add_u32 s55, s54, 5
  s_and_b32 s55, s55, 7
  s_lshl_b32 s33, s55, 7
  s_lshl_b32 s55, s55, 19
  s_add_u32 s33, s33, s53
  s_add_u32 m0, s43, 0x4000
  s_add_u32 s52, s55, 0x0
  buffer_load_dwordx4 v238, s[12:15], s52 offen lds
  s_add_u32 m0, s43, 0x4400
  s_add_u32 s52, s55, 0x8000
  buffer_load_dwordx4 v238, s[12:15], s52 offen lds
  s_add_u32 m0, s43, 0x4800
  s_add_u32 s52, s55, 0x10000
  buffer_load_dwordx4 v239, s[12:15], s52 offen lds
  s_add_u32 m0, s43, 0x4c00
  s_add_u32 s52, s55, 0x18000
  buffer_load_dwordx4 v239, s[12:15], s52 offen lds
  s_add_u32 m0, s32, 0xd000
  s_add_u32 s52, s33, 0x0
  buffer_load_dwordx4 v236, s[16:19], s52 offen lds
  s_add_u32 m0, s32, 0xe000
  s_add_u32 s52, s33, 0x8000
  buffer_load_dwordx4 v236, s[16:19], s52 offen lds
  s_add_u32 m0, s32, 0xf000
  s_add_u32 s52, s33, 0x10000
  buffer_load_dwordx4 v236, s[16:19], s52 offen lds
  s_add_u32 m0, s32, 0x10000
  s_add_u32 s52, s33, 0x18000
  buffer_load_dwordx4 v236, s[16:19], s52 offen lds
  s_add_u32 m0, s32, 0x11000
  s_add_u32 s52, s33, 0x20000
  buffer_load_dwordx4 v236, s[16:19], s52 offen lds
  v_mfma_f32_16x16x32_bf16 v[16:19], v[212:215], v[84:87], v[16:19]
  v_mfma_f32_16x16x32_bf16 v[48:51], v[212:215], v[88:91], v[48:51]
  v_mfma_f32_16x16x32_bf16 v[20:23], v[216:219], v[84:87], v[20:23]
  v_mfma_f32_16x16x32_bf16 v[52:55], v[216:219], v[88:91], v[52:55]
  v_mfma_f32_16x16x32_bf16 v[24:27], v[220:223], v[84:87], v[24:27]
  v_mfma_f32_16x16x32_bf16 v[56:59], v[220:223], v[88:91], v[56:59]
  v_mfma_f32_16x16x32_bf16 v[28:31], v[224:227], v[84:87], v[28:31]
  v_mfma_f32_16x16x32_bf16 v[60:63], v[224:227], v[88:91], v[60:63]
  ds_read_b64_tr_b16 v[212:213], v232 offset:0
  ds_read_b64_tr_b16 v[214:215], v232 offset:1024
  ds_read_b64_tr_b16 v[216:217], v233 offset:0
  ds_read_b64_tr_b16 v[218:219], v233 offset:1024
  ds_read_b64_tr_b16 v[220:221], v234 offset:0
  ds_read_b64_tr_b16 v[222:223], v234 offset:1024
  ds_read_b64_tr_b16 v[224:225], v235 offset:0
  ds_read_b64_tr_b16 v[226:227], v235 offset:1024
  s_waitcnt lgkmcnt(8)
  v_mfma_f32_16x16x32_bf16 v[0:3], v[196:199], v[72:75], v[0:3]
  v_mfma_f32_16x16x32_bf16 v[32:35], v[196:199], v[76:79], v[32:35]
  v_mfma_f32_16x16x32_bf16 v[4:7], v[200:203], v[72:75], v[4:7]
  v_mfma_f32_16x16x32_bf16 v[36:39], v[200:203], v[76:79], v[36:39]
  v_mfma_f32_16x16x32_bf16 v[8:11], v[204:207], v[72:75], v[8:11]
  v_mfma_f32_16x16x32_bf16 v[40:43], v[204:207], v[76:79], v[40:43]
  v_mfma_f32_16x16x32_bf16 v[12:15], v[208:211], v[72:75], v[12:15]
  v_mfma_f32_16x16x32_bf16 v[44:47], v[208:211], v[76:79], v[44:47]
  v_mfma_f32_16x16x32_bf16 v[64:67], v[196:199], v[80:83], v[64:67]
  v_mfma_f32_16x16x32_bf16 v[68:71], v[200:203], v[80:83], v[68:71]
  ds_read_b128 v[84:87], v97 offset:0
  ds_read_b128 v[88:91], v97 offset:2048
  ds_read_b128 v[92:95], v99 offset:0
  ds_read_b64_tr_b16 v[196:197], v228 offset:8192
  ds_read_b64_tr_b16 v[198:199], v228 offset:9216
  ds_read_b64_tr_b16 v[200:201], v229 offset:8192
  ds_read_b64_tr_b16 v[202:203], v229 offset:9216
  ds_read_b64_tr_b16 v[204:205], v230 offset:8192
  ds_read_b64_tr_b16 v[206:207], v230 offset:9216
  ds_read_b64_tr_b16 v[208:209], v231 offset:8192
  ds_read_b64_tr_b16 v[210:211], v231 offset:9216
  s_waitcnt lgkmcnt(11)
  v_mfma_f32_16x16x32_bf16 v[16:19], v[212:215], v[72:75], v[16:19]
  v_mfma_f32_16x16x32_bf16 v[48:51], v[212:215], v[76:79], v[48:51]
  v_mfma_f32_16x16x32_bf16 v[20:23], v[216:219], v[72:75], v[20:23]
  v_mfma_f32_16x16x32_bf16 v[52:55], v[216:219], v[76:79], v[52:55]
  v_mfma_f32_16x16x32_bf16 v[24:27], v[220:223], v[72:75], v[24:27]
  v_mfma_f32_16x16x32_bf16 v[56:59], v[220:223], v[76:79], v[56:59]
  v_mfma_f32_16x16x32_bf16 v[28:31], v[224:227], v[72:75], v[28:31]
  v_mfma_f32_16x16x32_bf16 v[60:63], v[224:227], v[76:79], v[60:63]
  ds_read_b64_tr_b16 v[212:213], v232 offset:8192
  ds_read_b64_tr_b16 v[214:215], v232 offset:9216
  ds_read_b64_tr_b16 v[216:217], v233 offset:8192
  ds_read_b64_tr_b16 v[218:219], v233 offset:9216
  ds_read_b64_tr_b16 v[220:221], v234 offset:8192
  ds_read_b64_tr_b16 v[222:223], v234 offset:9216
  ds_read_b64_tr_b16 v[224:225], v235 offset:8192
  ds_read_b64_tr_b16 v[226:227], v235 offset:9216
  s_waitcnt lgkmcnt(8)
  v_mfma_f32_16x16x32_bf16 v[0:3], v[196:199], v[84:87], v[0:3]
  v_mfma_f32_16x16x32_bf16 v[32:35], v[196:199], v[88:91], v[32:35]
  v_mfma_f32_16x16x32_bf16 v[4:7], v[200:203], v[84:87], v[4:7]
  v_mfma_f32_16x16x32_bf16 v[36:39], v[200:203], v[88:91], v[36:39]
  v_mfma_f32_16x16x32_bf16 v[8:11], v[204:207], v[84:87], v[8:11]
  v_mfma_f32_16x16x32_bf16 v[40:43], v[204:207], v[88:91], v[40:43]
  v_mfma_f32_16x16x32_bf16 v[12:15], v[208:211], v[84:87], v[12:15]
  v_mfma_f32_16x16x32_bf16 v[44:47], v[208:211], v[88:91], v[44:47]
  v_mfma_f32_16x16x32_bf16 v[64:67], v[196:199], v[92:95], v[64:67]
  v_mfma_f32_16x16x32_bf16 v[68:71], v[200:203], v[92:95], v[68:71]
  s_waitcnt vmcnt(0) lgkmcnt(0)
  s_barrier
  ds_read_b128 v[72:75], v96 offset:20480
  ds_read_b128 v[76:79], v96 offset:22528
  ds_read_b128 v[80:83], v98 offset:20480
  ds_read_b64_tr_b16 v[196:197], v228 offset:16384
  ds_read_b64_tr_b16 v[198:199], v228 offset:17408
  ds_read_b64_tr_b16 v[200:201], v229 offset:16384
  ds_read_b64_tr_b16 v[202:203], v229 offset:17408
  ds_read_b64_tr_b16 v[204:205], v230 offset:16384
  ds_read_b64_tr_b16 v[206:207], v230 offset:17408
  ds_read_b64_tr_b16 v[208:209], v231 offset:16384
  ds_read_b64_tr_b16 v[210:211], v231 offset:17408
  s_add_u32 s55, s54, 6
  s_and_b32 s55, s55, 7
  s_lshl_b32 s33, s55, 7
  s_lshl_b32 s55, s55, 19
  s_add_u32 s33, s33, s53
  s_add_u32 m0, s43, 0x0
  s_add_u32 s52, s55, 0x0
  buffer_load_dwordx4 v238, s[12:15], s52 offen lds
  s_add_u32 m0, s43, 0x400
  s_add_u32 s52, s55, 0x8000
  buffer_load_dwordx4 v238, s[12:15], s52 offen lds
  s_add_u32 m0, s43, 0x800
  s_add_u32 s52, s55, 0x10000
  buffer_load_dwordx4 v239, s[12:15], s52 offen lds
  s_add_u32 m0, s43, 0xc00
  s_add_u32 s52, s55, 0x18000
  buffer_load_dwordx4 v239, s[12:15], s52 offen lds
  s_add_u32 m0, s32, 0x8000
  s_add_u32 s52, s33, 0x0
  buffer_load_dwordx4 v236, s[16:19], s52 offen lds
  s_add_u32 m0, s32, 0x9000
  s_add_u32 s52, s33, 0x8000
  buffer_load_dwordx4 v236, s[16:19], s52 offen lds
  s_add_u32 m0, s32, 0xa000
  s_add_u32 s52, s33, 0x10000
  buffer_load_dwordx4 v236, s[16:19], s52 offen lds
  s_add_u32 m0, s32, 0xb000
  s_add_u32 s52, s33, 0x18000
  buffer_load_dwordx4 v236, s[16:19], s52 offen lds
  s_add_u32 m0, s32, 0xc000
  s_add_u32 s52, s33, 0x20000
  buffer_load_dwordx4 v236, s[16:19], s52 offen lds
  v_mfma_f32_16x16x32_bf16 v[16:19], v[212:215], v[84:87], v[16:19]
  v_mfma_f32_16x16x32_bf16 v[48:51], v[212:215], v[88:91], v[48:51]
  v_mfma_f32_16x16x32_bf16 v[20:23], v[216:219], v[84:87], v[20:23]
  v_mfma_f32_16x16x32_bf16 v[52:55], v[216:219], v[88:91], v[52:55]
  v_mfma_f32_16x16x32_bf16 v[24:27], v[220:223], v[84:87], v[24:27]
  v_mfma_f32_16x16x32_bf16 v[56:59], v[220:223], v[88:91], v[56:59]
  v_mfma_f32_16x16x32_bf16 v[28:31], v[224:227], v[84:87], v[28:31]
  v_mfma_f32_16x16x32_bf16 v[60:63], v[224:227], v[88:91], v[60:63]
  ds_read_b64_tr_b16 v[212:213], v232 offset:16384
  ds_read_b64_tr_b16 v[214:215], v232 offset:17408
  ds_read_b64_tr_b16 v[216:217], v233 offset:16384
  ds_read_b64_tr_b16 v[218:219], v233 offset:17408
  ds_read_b64_tr_b16 v[220:221], v234 offset:16384
  ds_read_b64_tr_b16 v[222:223], v234 offset:17408
  ds_read_b64_tr_b16 v[224:225], v235 offset:16384
  ds_read_b64_tr_b16 v[226:227], v235 offset:17408
  s_waitcnt lgkmcnt(8)
  v_mfma_f32_16x16x32_bf16 v[0:3], v[196:199], v[72:75], v[0:3]
  v_mfma_f32_16x16x32_bf16 v[32:35], v[196:199], v[76:79], v[32:35]
  v_mfma_f32_16x16x32_bf16 v[4:7], v[200:203], v[72:75], v[4:7]
  v_mfma_f32_16x16x32_bf16 v[36:39], v[200:203], v[76:79], v[36:39]
  v_mfma_f32_16x16x32_bf16 v[8:11], v[204:207], v[72:75], v[8:11]
  v_mfma_f32_16x16x32_bf16 v[40:43], v[204:207], v[76:79], v[40:43]
  v_mfma_f32_16x16x32_bf16 v[12:15], v[208:211], v[72:75], v[12:15]
  v_mfma_f32_16x16x32_bf16 v[44:47], v[208:211], v[76:79], v[44:47]
  v_mfma_f32_16x16x32_bf16 v[64:67], v[196:199], v[80:83], v[64:67]
  v_mfma_f32_16x16x32_bf16 v[68:71], v[200:203], v[80:83], v[68:71]
  ds_read_b128 v[84:87], v97 offset:20480
  ds_read_b128 v[88:91], v97 offset:22528
  ds_read_b128 v[92:95], v99 offset:20480
  ds_read_b64_tr_b16 v[196:197], v228 offset:24576
  ds_read_b64_tr_b16 v[198:199], v228 offset:25600
  ds_read_b64_tr_b16 v[200:201], v229 offset:24576
  ds_read_b64_tr_b16 v[202:203], v229 offset:25600
  ds_read_b64_tr_b16 v[204:205], v230 offset:24576
  ds_read_b64_tr_b16 v[206:207], v230 offset:25600
  ds_read_b64_tr_b16 v[208:209], v231 offset:24576
  ds_read_b64_tr_b16 v[210:211], v231 offset:25600
  s_waitcnt lgkmcnt(11)
  v_mfma_f32_16x16x32_bf16 v[16:19], v[212:215], v[72:75], v[16:19]
  v_mfma_f32_16x16x32_bf16 v[48:51], v[212:215], v[76:79], v[48:51]
  v_mfma_f32_16x16x32_bf16 v[20:23], v[216:219], v[72:75], v[20:23]
  v_mfma_f32_16x16x32_bf16 v[52:55], v[216:219], v[76:79], v[52:55]
  v_mfma_f32_16x16x32_bf16 v[24:27], v[220:223], v[72:75], v[24:27]
  v_mfma_f32_16x16x32_bf16 v[56:59], v[220:223], v[76:79], v[56:59]
  v_mfma_f32_16x16x32_bf16 v[28:31], v[224:227], v[72:75], v[28:31]
  v_mfma_f32_16x16x32_bf16 v[60:63], v[224:227], v[76:79], v[60:63]
  ds_read_b64_tr_b16 v[212:213], v232 offset:24576
  ds_read_b64_tr_b16 v[214:215], v232 offset:25600
  ds_read_b64_tr_b16 v[216:217], v233 offset:24576
  ds_read_b64_tr_b16 v[218:219], v233 offset:25600
  ds_read_b64_tr_b16 v[220:221], v234 offset:24576
  ds_read_b64_tr_b16 v[222:223], v234 offset:25600
  ds_read_b64_tr_b16 v[224:225], v235 offset:24576
  ds_read_b64_tr_b16 v[226:227], v235 offset:25600
  s_waitcnt lgkmcnt(8)
  v_mfma_f32_16x16x32_bf16 v[0:3], v[196:199], v[84:87], v[0:3]
  v_mfma_f32_16x16x32_bf16 v[32:35], v[196:199], v[88:91], v[32:35]
  v_mfma_f32_16x16x32_bf16 v[4:7], v[200:203], v[84:87], v[4:7]
  v_mfma_f32_16x16x32_bf16 v[36:39], v[200:203], v[88:91], v[36:39]
  v_mfma_f32_16x16x32_bf16 v[8:11], v[204:207], v[84:87], v[8:11]
  v_mfma_f32_16x16x32_bf16 v[40:43], v[204:207], v[88:91], v[40:43]
  v_mfma_f32_16x16x32_bf16 v[12:15], v[208:211], v[84:87], v[12:15]
  v_mfma_f32_16x16x32_bf16 v[44:47], v[208:211], v[88:91], v[44:47]
  v_mfma_f32_16x16x32_bf16 v[64:67], v[196:199], v[92:95], v[64:67]
  v_mfma_f32_16x16x32_bf16 v[68:71], v[200:203], v[92:95], v[68:71]
  s_waitcnt vmcnt(0) lgkmcnt(0)
  s_barrier
  ds_read_b128 v[72:75], v96 offset:0
  ds_read_b128 v[76:79], v96 offset:2048
  ds_read_b128 v[80:83], v98 offset:0
  ds_read_b64_tr_b16 v[196:197], v228 offset:0
  ds_read_b64_tr_b16 v[198:199], v228 offset:1024
  ds_read_b64_tr_b16 v[200:201], v229 offset:0
  ds_read_b64_tr_b16 v[202:203], v229 offset:1024
  ds_read_b64_tr_b16 v[204:205], v230 offset:0
  ds_read_b64_tr_b16 v[206:207], v230 offset:1024
  ds_read_b64_tr_b16 v[208:209], v231 offset:0
  ds_read_b64_tr_b16 v[210:211], v231 offset:1024
  s_add_u32 s55, s54, 7
  s_and_b32 s55, s55, 7
  s_lshl_b32 s33, s55, 7
  s_lshl_b32 s55, s55, 19
  s_add_u32 s33, s33, s53
  s_add_u32 m0, s43, 0x4000
  s_add_u32 s52, s55, 0x0
  buffer_load_dwordx4 v238, s[12:15], s52 offen lds
  s_add_u32 m0, s43, 0x4400
  s_add_u32 s52, s55, 0x8000
  buffer_load_dwordx4 v238, s[12:15], s52 offen lds
  s_add_u32 m0, s43, 0x4800
  s_add_u32 s52, s55, 0x10000
  buffer_load_dwordx4 v239, s[12:15], s52 offen lds
  s_add_u32 m0, s43, 0x4c00
  s_add_u32 s52, s55, 0x18000
  buffer_load_dwordx4 v239, s[12:15], s52 offen lds
  s_add_u32 m0, s32, 0xd000
  s_add_u32 s52, s33, 0x0
  buffer_load_dwordx4 v236, s[16:19], s52 offen lds
  s_add_u32 m0, s32, 0xe000
  s_add_u32 s52, s33, 0x8000
  buffer_load_dwordx4 v236, s[16:19], s52 offen lds
  s_add_u32 m0, s32, 0xf000
  s_add_u32 s52, s33, 0x10000
  buffer_load_dwordx4 v236, s[16:19], s52 offen lds
  s_add_u32 m0, s32, 0x10000
  s_add_u32 s52, s33, 0x18000
  buffer_load_dwordx4 v236, s[16:19], s52 offen lds
  s_add_u32 m0, s32, 0x11000
  s_add_u32 s52, s33, 0x20000
  buffer_load_dwordx4 v236, s[16:19], s52 offen lds
  v_mfma_f32_16x16x32_bf16 v[16:19], v[212:215], v[84:87], v[16:19]
  v_mfma_f32_16x16x32_bf16 v[48:51], v[212:215], v[88:91], v[48:51]
  v_mfma_f32_16x16x32_bf16 v[20:23], v[216:219], v[84:87], v[20:23]
  v_mfma_f32_16x16x32_bf16 v[52:55], v[216:219], v[88:91], v[52:55]
  v_mfma_f32_16x16x32_bf16 v[24:27], v[220:223], v[84:87], v[24:27]
  v_mfma_f32_16x16x32_bf16 v[56:59], v[220:223], v[88:91], v[56:59]
  v_mfma_f32_16x16x32_bf16 v[28:31], v[224:227], v[84:87], v[28:31]
  v_mfma_f32_16x16x32_bf16 v[60:63], v[224:227], v[88:91], v[60:63]
  ds_read_b64_tr_b16 v[212:213], v232 offset:0
  ds_read_b64_tr_b16 v[214:215], v232 offset:1024
  ds_read_b64_tr_b16 v[216:217], v233 offset:0
  ds_read_b64_tr_b16 v[218:219], v233 offset:1024
  ds_read_b64_tr_b16 v[220:221], v234 offset:0
  ds_read_b64_tr_b16 v[222:223], v234 offset:1024
  ds_read_b64_tr_b16 v[224:225], v235 offset:0
  ds_read_b64_tr_b16 v[226:227], v235 offset:1024
  s_waitcnt lgkmcnt(8)
  v_mfma_f32_16x16x32_bf16 v[0:3], v[196:199], v[72:75], v[0:3]
  v_mfma_f32_16x16x32_bf16 v[32:35], v[196:199], v[76:79], v[32:35]
  v_mfma_f32_16x16x32_bf16 v[4:7], v[200:203], v[72:75], v[4:7]
  v_mfma_f32_16x16x32_bf16 v[36:39], v[200:203], v[76:79], v[36:39]
  v_mfma_f32_16x16x32_bf16 v[8:11], v[204:207], v[72:75], v[8:11]
  v_mfma_f32_16x16x32_bf16 v[40:43], v[204:207], v[76:79], v[40:43]
  v_mfma_f32_16x16x32_bf16 v[12:15], v[208:211], v[72:75], v[12:15]
  v_mfma_f32_16x16x32_bf16 v[44:47], v[208:211], v[76:79], v[44:47]
  v_mfma_f32_16x16x32_bf16 v[64:67], v[196:199], v[80:83], v[64:67]
  v_mfma_f32_16x16x32_bf16 v[68:71], v[200:203], v[80:83], v[68:71]
  ds_read_b128 v[84:87], v97 offset:0
  ds_read_b128 v[88:91], v97 offset:2048
  ds_read_b128 v[92:95], v99 offset:0
  ds_read_b64_tr_b16 v[196:197], v228 offset:8192
  ds_read_b64_tr_b16 v[198:199], v228 offset:9216
  ds_read_b64_tr_b16 v[200:201], v229 offset:8192
  ds_read_b64_tr_b16 v[202:203], v229 offset:9216
  ds_read_b64_tr_b16 v[204:205], v230 offset:8192
  ds_read_b64_tr_b16 v[206:207], v230 offset:9216
  ds_read_b64_tr_b16 v[208:209], v231 offset:8192
  ds_read_b64_tr_b16 v[210:211], v231 offset:9216
  s_waitcnt lgkmcnt(11)
  v_mfma_f32_16x16x32_bf16 v[16:19], v[212:215], v[72:75], v[16:19]
  v_mfma_f32_16x16x32_bf16 v[48:51], v[212:215], v[76:79], v[48:51]
  v_mfma_f32_16x16x32_bf16 v[20:23], v[216:219], v[72:75], v[20:23]
  v_mfma_f32_16x16x32_bf16 v[52:55], v[216:219], v[76:79], v[52:55]
  v_mfma_f32_16x16x32_bf16 v[24:27], v[220:223], v[72:75], v[24:27]
  v_mfma_f32_16x16x32_bf16 v[56:59], v[220:223], v[76:79], v[56:59]
  v_mfma_f32_16x16x32_bf16 v[28:31], v[224:227], v[72:75], v[28:31]
  v_mfma_f32_16x16x32_bf16 v[60:63], v[224:227], v[76:79], v[60:63]
  ds_read_b64_tr_b16 v[212:213], v232 offset:8192
  ds_read_b64_tr_b16 v[214:215], v232 offset:9216
  ds_read_b64_tr_b16 v[216:217], v233 offset:8192
  ds_read_b64_tr_b16 v[218:219], v233 offset:9216
  ds_read_b64_tr_b16 v[220:221], v234 offset:8192
  ds_read_b64_tr_b16 v[222:223], v234 offset:9216
  ds_read_b64_tr_b16 v[224:225], v235 offset:8192
  ds_read_b64_tr_b16 v[226:227], v235 offset:9216
  s_waitcnt lgkmcnt(8)
  v_mfma_f32_16x16x32_bf16 v[0:3], v[196:199], v[84:87], v[0:3]
  v_mfma_f32_16x16x32_bf16 v[32:35], v[196:199], v[88:91], v[32:35]
  v_mfma_f32_16x16x32_bf16 v[4:7], v[200:203], v[84:87], v[4:7]
  v_mfma_f32_16x16x32_bf16 v[36:39], v[200:203], v[88:91], v[36:39]
  v_mfma_f32_16x16x32_bf16 v[8:11], v[204:207], v[84:87], v[8:11]
  v_mfma_f32_16x16x32_bf16 v[40:43], v[204:207], v[88:91], v[40:43]
  v_mfma_f32_16x16x32_bf16 v[12:15], v[208:211], v[84:87], v[12:15]
  v_mfma_f32_16x16x32_bf16 v[44:47], v[208:211], v[88:91], v[44:47]
  v_mfma_f32_16x16x32_bf16 v[64:67], v[196:199], v[92:95], v[64:67]
  v_mfma_f32_16x16x32_bf16 v[68:71], v[200:203], v[92:95], v[68:71]
  s_waitcnt vmcnt(0) lgkmcnt(0)
  s_barrier
  ds_read_b128 v[72:75], v96 offset:20480
  ds_read_b128 v[76:79], v96 offset:22528
  ds_read_b128 v[80:83], v98 offset:20480
  ds_read_b64_tr_b16 v[196:197], v228 offset:16384
  ds_read_b64_tr_b16 v[198:199], v228 offset:17408
  ds_read_b64_tr_b16 v[200:201], v229 offset:16384
  ds_read_b64_tr_b16 v[202:203], v229 offset:17408
  ds_read_b64_tr_b16 v[204:205], v230 offset:16384
  ds_read_b64_tr_b16 v[206:207], v230 offset:17408
  ds_read_b64_tr_b16 v[208:209], v231 offset:16384
  ds_read_b64_tr_b16 v[210:211], v231 offset:17408
  s_add_u32 m0, s27, 0x0
  s_nop 0
  buffer_load_dwordx4 v240, s[4:7], s25 offen nt lds
  s_add_u32 m0, s27, 0x400
  s_nop 0
  buffer_load_dwordx4 v241, s[4:7], s25 offen nt lds
  s_add_u32 m0, s27, 0x2000
  s_nop 0
  buffer_load_dwordx4 v242, s[8:11], s25 offen nt lds
  s_add_u32 m0, s27, 0x2400
  s_nop 0
  buffer_load_dwordx4 v243, s[8:11], s25 offen nt lds
  s_add_u32 s25, s25, 8192
  s_add_u32 m0, s27, 0x8000
  s_nop 0
  buffer_load_dwordx4 v240, s[4:7], s25 offen nt lds
  s_add_u32 m0, s27, 0x8400
  s_nop 0
  buffer_load_dwordx4 v241, s[4:7], s25 offen nt lds
  s_add_u32 m0, s27, 0xa000
  s_nop 0
  buffer_load_dwordx4 v242, s[8:11], s25 offen nt lds
  s_add_u32 m0, s27, 0xa400
  s_nop 0
  buffer_load_dwordx4 v243, s[8:11], s25 offen nt lds
  s_add_u32 s25, s25, 8192
  v_mfma_f32_16x16x32_bf16 v[16:19], v[212:215], v[84:87], v[16:19]
  v_mfma_f32_16x16x32_bf16 v[48:51], v[212:215], v[88:91], v[48:51]
  v_mfma_f32_16x16x32_bf16 v[20:23], v[216:219], v[84:87], v[20:23]
  v_mfma_f32_16x16x32_bf16 v[52:55], v[216:219], v[88:91], v[52:55]
  v_mfma_f32_16x16x32_bf16 v[24:27], v[220:223], v[84:87], v[24:27]
  v_mfma_f32_16x16x32_bf16 v[56:59], v[220:223], v[88:91], v[56:59]
  v_mfma_f32_16x16x32_bf16 v[28:31], v[224:227], v[84:87], v[28:31]
  v_mfma_f32_16x16x32_bf16 v[60:63], v[224:227], v[88:91], v[60:63]
  ds_read_b64_tr_b16 v[212:213], v232 offset:16384
  ds_read_b64_tr_b16 v[214:215], v232 offset:17408
  ds_read_b64_tr_b16 v[216:217], v233 offset:16384
  ds_read_b64_tr_b16 v[218:219], v233 offset:17408
  ds_read_b64_tr_b16 v[220:221], v234 offset:16384
  ds_read_b64_tr_b16 v[222:223], v234 offset:17408
  ds_read_b64_tr_b16 v[224:225], v235 offset:16384
  ds_read_b64_tr_b16 v[226:227], v235 offset:17408
  s_waitcnt lgkmcnt(8)
  v_mfma_f32_16x16x32_bf16 v[0:3], v[196:199], v[72:75], v[0:3]
  v_mfma_f32_16x16x32_bf16 v[32:35], v[196:199], v[76:79], v[32:35]
  v_mfma_f32_16x16x32_bf16 v[4:7], v[200:203], v[72:75], v[4:7]
  v_mfma_f32_16x16x32_bf16 v[36:39], v[200:203], v[76:79], v[36:39]
  v_mfma_f32_16x16x32_bf16 v[8:11], v[204:207], v[72:75], v[8:11]
  v_mfma_f32_16x16x32_bf16 v[40:43], v[204:207], v[76:79], v[40:43]
  v_mfma_f32_16x16x32_bf16 v[12:15], v[208:211], v[72:75], v[12:15]
  v_mfma_f32_16x16x32_bf16 v[44:47], v[208:211], v[76:79], v[44:47]
  v_mfma_f32_16x16x32_bf16 v[64:67], v[196:199], v[80:83], v[64:67]
  v_mfma_f32_16x16x32_bf16 v[68:71], v[200:203], v[80:83], v[68:71]
  ds_read_b128 v[84:87], v97 offset:20480
  ds_read_b128 v[88:91], v97 offset:22528
  ds_read_b128 v[92:95], v99 offset:20480
  ds_read_b64_tr_b16 v[196:197], v228 offset:24576
  ds_read_b64_tr_b16 v[198:199], v228 offset:25600
  ds_read_b64_tr_b16 v[200:201], v229 offset:24576
  ds_read_b64_tr_b16 v[202:203], v229 offset:25600
  ds_read_b64_tr_b16 v[204:205], v230 offset:24576
  ds_read_b64_tr_b16 v[206:207], v230 offset:25600
  ds_read_b64_tr_b16 v[208:209], v231 offset:24576
  ds_read_b64_tr_b16 v[210:211], v231 offset:25600
  s_waitcnt lgkmcnt(11)
  v_mfma_f32_16x16x32_bf16 v[16:19], v[212:215], v[72:75], v[16:19]
  v_mfma_f32_16x16x32_bf16 v[48:51], v[212:215], v[76:79], v[48:51]
  v_mfma_f32_16x16x32_bf16 v[20:23], v[216:219], v[72:75], v[20:23]
  v_mfma_f32_16x16x32_bf16 v[52:55], v[216:219], v[76:79], v[52:55]
  v_mfma_f32_16x16x32_bf16 v[24:27], v[220:223], v[72:75], v[24:27]
  v_mfma_f32_16x16x32_bf16 v[56:59], v[220:223], v[76:79], v[56:59]
  v_mfma_f32_16x16x32_bf16 v[28:31], v[224:227], v[72:75], v[28:31]
  v_mfma_f32_16x16x32_bf16 v[60:63], v[224:227], v[76:79], v[60:63]
  ds_read_b64_tr_b16 v[212:213], v232 offset:24576
  ds_read_b64_tr_b16 v[214:215], v232 offset:25600
  ds_read_b64_tr_b16 v[216:217], v233 offset:24576
  ds_read_b64_tr_b16 v[218:219], v233 offset:25600
  ds_read_b64_tr_b16 v[220:221], v234 offset:24576
  ds_read_b64_tr_b16 v[222:223], v234 offset:25600
  ds_read_b64_tr_b16 v[224:225], v235 offset:24576
  ds_read_b64_tr_b16 v[226:227], v235 offset:25600
  s_waitcnt lgkmcnt(8)
  v_mfma_f32_16x16x32_bf16 v[0:3], v[196:199], v[84:87], v[0:3]
  v_mfma_f32_16x16x32_bf16 v[32:35], v[196:199], v[88:91], v[32:35]
  v_mfma_f32_16x16x32_bf16 v[4:7], v[200:203], v[84:87], v[4:7]
  v_mfma_f32_16x16x32_bf16 v[36:39], v[200:203], v[88:91], v[36:39]
  v_mfma_f32_16x16x32_bf16 v[8:11], v[204:207], v[84:87], v[8:11]
  v_mfma_f32_16x16x32_bf16 v[40:43], v[204:207], v[88:91], v[40:43]
  v_mfma_f32_16x16x32_bf16 v[12:15], v[208:211], v[84:87], v[12:15]
  v_mfma_f32_16x16x32_bf16 v[44:47], v[208:211], v[88:91], v[44:47]
  v_mfma_f32_16x16x32_bf16 v[64:67], v[196:199], v[92:95], v[64:67]
  v_mfma_f32_16x16x32_bf16 v[68:71], v[200:203], v[92:95], v[68:71]
  s_waitcnt lgkmcnt(0)
  v_mfma_f32_16x16x32_bf16 v[16:19], v[212:215], v[84:87], v[16:19]
  v_mfma_f32_16x16x32_bf16 v[48:51], v[212:215], v[88:91], v[48:51]
  v_mfma_f32_16x16x32_bf16 v[20:23], v[216:219], v[84:87], v[20:23]
  v_mfma_f32_16x16x32_bf16 v[52:55], v[216:219], v[88:91], v[52:55]
  v_mfma_f32_16x16x32_bf16 v[24:27], v[220:223], v[84:87], v[24:27]
  v_mfma_f32_16x16x32_bf16 v[56:59], v[220:223], v[88:91], v[56:59]
  v_mfma_f32_16x16x32_bf16 v[28:31], v[224:227], v[84:87], v[28:31]
  v_mfma_f32_16x16x32_bf16 v[60:63], v[224:227], v[88:91], v[60:63]
  s_mov_b32 s33, 0x3e0293ee
  s_nop 7
  v_mul_f32 v0, s33, v0
  v_mul_f32 v1, s33, v1
  v_mul_f32 v2, s33, v2
  v_mul_f32 v3, s33, v3
  v_mul_f32 v4, s33, v4
  v_mul_f32 v5, s33, v5
  v_mul_f32 v6, s33, v6
  v_mul_f32 v7, s33, v7
  v_mul_f32 v8, s33, v8
  v_mul_f32 v9, s33, v9
  v_mul_f32 v10, s33, v10
  v_mul_f32 v11, s33, v11
  v_mul_f32 v12, s33, v12
  v_mul_f32 v13, s33, v13
  v_mul_f32 v14, s33, v14
  v_mul_f32 v15, s33, v15
  v_mul_f32 v16, s33, v16
  v_mul_f32 v17, s33, v17
  v_mul_f32 v18, s33, v18
  v_mul_f32 v19, s33, v19
  v_mul_f32 v20, s33, v20
  v_mul_f32 v21, s33, v21
  v_mul_f32 v22, s33, v22
  v_mul_f32 v23, s33, v23
  v_mul_f32 v24, s33, v24
  v_mul_f32 v25, s33, v25
  v_mul_f32 v26, s33, v26
  v_mul_f32 v27, s33, v27
  v_mul_f32 v28, s33, v28
  v_mul_f32 v29, s33, v29
  v_mul_f32 v30, s33, v30
  v_mul_f32 v31, s33, v31
  v_mul_f32 v32, s33, v32
  v_mul_f32 v33, s33, v33
  v_mul_f32 v34, s33, v34
  v_mul_f32 v35, s33, v35
  v_mul_f32 v36, s33, v36
  v_mul_f32 v37, s33, v37
  v_mul_f32 v38, s33, v38
  v_mul_f32 v39, s33, v39
  v_mul_f32 v40, s33, v40
  v_mul_f32 v41, s33, v41
  v_mul_f32 v42, s33, v42
  v_mul_f32 v43, s33, v43
  v_mul_f32 v44, s33, v44
  v_mul_f32 v45, s33, v45
  v_mul_f32 v46, s33, v46
  v_mul_f32 v47, s33, v47
  v_mul_f32 v48, s33, v48
  v_mul_f32 v49, s33, v49
  v_mul_f32 v50, s33, v50
  v_mul_f32 v51, s33, v51
  v_mul_f32 v52, s33, v52
  v_mul_f32 v53, s33, v53
  v_mul_f32 v54, s33, v54
  v_mul_f32 v55, s33, v55
  v_mul_f32 v56, s33, v56
  v_mul_f32 v57, s33, v57
  v_mul_f32 v58, s33, v58
  v_mul_f32 v59, s33, v59
  v_mul_f32 v60, s33, v60
  v_mul_f32 v61, s33, v61
  v_mul_f32 v62, s33, v62
  v_mul_f32 v63, s33, v63
  v_mul_f32 v64, s33, v64
  v_mul_f32 v65, s33, v65
  v_mul_f32 v66, s33, v66
  v_mul_f32 v67, s33, v67
  v_mul_f32 v68, s33, v68
  v_mul_f32 v69, s33, v69
  v_mul_f32 v70, s33, v70
  v_mul_f32 v71, s33, v71
  v_cvt_pk_bf16_f32 v108, v0, v1
  v_cvt_pk_bf16_f32 v109, v2, v3
  v_cvt_pk_bf16_f32 v110, v4, v5
  v_cvt_pk_bf16_f32 v111, v6, v7
  v_cvt_pk_bf16_f32 v124, v32, v33
  v_cvt_pk_bf16_f32 v125, v34, v35
  v_cvt_pk_bf16_f32 v126, v36, v37
  v_cvt_pk_bf16_f32 v127, v38, v39
  v_cvt_pk_bf16_f32 v112, v8, v9
  v_cvt_pk_bf16_f32 v113, v10, v11
  v_cvt_pk_bf16_f32 v114, v12, v13
  v_cvt_pk_bf16_f32 v115, v14, v15
  v_cvt_pk_bf16_f32 v128, v40, v41
  v_cvt_pk_bf16_f32 v129, v42, v43
  v_cvt_pk_bf16_f32 v130, v44, v45
  v_cvt_pk_bf16_f32 v131, v46, v47
  v_cvt_pk_bf16_f32 v116, v16, v17
  v_cvt_pk_bf16_f32 v117, v18, v19
  v_cvt_pk_bf16_f32 v118, v20, v21
  v_cvt_pk_bf16_f32 v119, v22, v23
  v_cvt_pk_bf16_f32 v132, v48, v49
  v_cvt_pk_bf16_f32 v133, v50, v51
  v_cvt_pk_bf16_f32 v134, v52, v53
  v_cvt_pk_bf16_f32 v135, v54, v55
  v_cvt_pk_bf16_f32 v120, v24, v25
  v_cvt_pk_bf16_f32 v121, v26, v27
  v_cvt_pk_bf16_f32 v122, v28, v29
  v_cvt_pk_bf16_f32 v123, v30, v31
  v_cvt_pk_bf16_f32 v136, v56, v57
  v_cvt_pk_bf16_f32 v137, v58, v59
  v_cvt_pk_bf16_f32 v138, v60, v61
  v_cvt_pk_bf16_f32 v139, v62, v63
  v_cvt_pk_bf16_f32 v244, v64, v65
  v_cvt_pk_bf16_f32 v245, v66, v67
  v_cvt_pk_bf16_f32 v246, v68, v69
  v_cvt_pk_bf16_f32 v247, v70, v71
  s_nop 1
  v_permlane32_swap_b32 v108, v110
  v_permlane32_swap_b32 v109, v111
  s_nop 1
  v_permlane16_swap_b32 v108, v110
  v_permlane16_swap_b32 v109, v111
  v_permlane32_swap_b32 v124, v126
  v_permlane32_swap_b32 v125, v127
  s_nop 1
  v_permlane16_swap_b32 v124, v126
  v_permlane16_swap_b32 v125, v127
  v_permlane32_swap_b32 v112, v114
  v_permlane32_swap_b32 v113, v115
  s_nop 1
  v_permlane16_swap_b32 v112, v114
  v_permlane16_swap_b32 v113, v115
  v_permlane32_swap_b32 v128, v130
  v_permlane32_swap_b32 v129, v131
  s_nop 1
  v_permlane16_swap_b32 v128, v130
  v_permlane16_swap_b32 v129, v131
  v_permlane32_swap_b32 v116, v118
  v_permlane32_swap_b32 v117, v119
  s_nop 1
  v_permlane16_swap_b32 v116, v118
  v_permlane16_swap_b32 v117, v119
  v_permlane32_swap_b32 v132, v134
  v_permlane32_swap_b32 v133, v135
  s_nop 1
  v_permlane16_swap_b32 v132, v134
  v_permlane16_swap_b32 v133, v135
  v_permlane32_swap_b32 v120, v122
  v_permlane32_swap_b32 v121, v123
  s_nop 1
  v_permlane16_swap_b32 v120, v122
  v_permlane16_swap_b32 v121, v123
  v_permlane32_swap_b32 v136, v138
  v_permlane32_swap_b32 v137, v139
  s_nop 1
  v_permlane16_swap_b32 v136, v138
  v_permlane16_swap_b32 v137, v139
  v_permlane32_swap_b32 v244, v246
  v_permlane32_swap_b32 v245, v247
  s_nop 1
  v_permlane16_swap_b32 v244, v246
  v_permlane16_swap_b32 v245, v247
  s_nop 1
  s_lshl_b32 s33, s24, 10
  s_add_u32 s33, s33, 0x12000
  v_add_u32 v248, s33, v252
  v_add_u32 v249, 0x12000, v252
  ds_write_b128 v248, v[244:247]
  v_lshrrev_b32 v2, 4, v252
  v_lshrrev_b32 v3, 4, v2
  v_and_b32 v4, 15, v2
  s_add_u32 s33, s24, 0
  s_and_b32 s33, s33, 3
  s_lshl_b32 s33, s33, 2
  v_add_u32 v5, s33, v3
  v_xor_b32 v5, v5, v4
  v_lshlrev_b32 v5, 4, v5
  v_lshl_add_u32 v228, v4, 8, v5
  s_add_u32 s33, s24, 1
  s_and_b32 s33, s33, 3
  s_lshl_b32 s33, s33, 2
  v_add_u32 v5, s33, v3
  v_xor_b32 v5, v5, v4
  v_lshlrev_b32 v5, 4, v5
  v_lshl_add_u32 v229, v4, 8, v5
  s_add_u32 s33, s24, 2
  s_and_b32 s33, s33, 3
  s_lshl_b32 s33, s33, 2
  v_add_u32 v5, s33, v3
  v_xor_b32 v5, v5, v4
  v_lshlrev_b32 v5, 4, v5
  v_lshl_add_u32 v230, v4, 8, v5
  s_add_u32 s33, s24, 3
  s_and_b32 s33, s33, 3
  s_lshl_b32 s33, s33, 2
  v_add_u32 v5, s33, v3
  v_xor_b32 v5, v5, v4
  v_lshlrev_b32 v5, 4, v5
  v_lshl_add_u32 v231, v4, 8, v5
  v_lshrrev_b32 v5, 2, v4
  v_lshl_add_u32 v5, v3, 2, v5
  v_and_b32 v6, 7, v5
  v_bfe_u32 v7, v4, 1, 1
  v_lshlrev_b32 v7, 4, v7
  v_and_b32 v8, 1, v4
  v_lshl_add_u32 v7, v8, 3, v7
  v_lshl_add_u32 v7, v5, 8, v7
  v_xor_b32 v8, 0, v6
  v_lshl_add_u32 v232, v8, 5, v7
  v_xor_b32 v8, 1, v6
  v_lshl_add_u32 v233, v8, 5, v7
  v_xor_b32 v8, 2, v6
  v_lshl_add_u32 v234, v8, 5, v7
  v_xor_b32 v8, 3, v6
  v_lshl_add_u32 v235, v8, 5, v7
  v_xor_b32 v8, 4, v6
  v_lshl_add_u32 v236, v8, 5, v7
  v_xor_b32 v8, 5, v6
  v_lshl_add_u32 v237, v8, 5, v7
  v_xor_b32 v8, 6, v6
  v_lshl_add_u32 v238, v8, 5, v7
  v_xor_b32 v8, 7, v6
  v_lshl_add_u32 v239, v8, 5, v7
  s_waitcnt lgkmcnt(0)
  s_barrier
  s_add_u32 m0, s27, 0x4000
  s_nop 0
  buffer_load_dwordx4 v240, s[4:7], s25 offen nt lds
  s_add_u32 m0, s27, 0x4400
  s_nop 0
  buffer_load_dwordx4 v241, s[4:7], s25 offen nt lds
  s_add_u32 m0, s27, 0x6000
  s_nop 0
  buffer_load_dwordx4 v242, s[8:11], s25 offen nt lds
  s_add_u32 m0, s27, 0x6400
  s_nop 0
  buffer_load_dwordx4 v243, s[8:11], s25 offen nt lds
  s_add_u32 s25, s25, 8192
  s_add_u32 s33, s24, 0
  s_and_b32 s33, s33, 3
  s_lshl_b32 s33, s33, 10
  v_add_u32 v244, s33, v249
  ds_read_b128 v[140:143], v244
  s_add_u32 s33, s24, 1
  s_and_b32 s33, s33, 3
  s_lshl_b32 s33, s33, 10
  v_add_u32 v245, s33, v249
  ds_read_b128 v[144:147], v245
  s_add_u32 s33, s24, 2
  s_and_b32 s33, s33, 3
  s_lshl_b32 s33, s33, 10
  v_add_u32 v246, s33, v249
  ds_read_b128 v[148:151], v246
  s_add_u32 s33, s24, 3
  s_and_b32 s33, s33, 3
  s_lshl_b32 s33, s33, 10
  v_add_u32 v247, s33, v249
  ds_read_b128 v[152:155], v247
  v_mov_b32 v0, 0
  v_mov_b32 v1, 0
  v_mov_b32 v2, 0
  v_mov_b32 v3, 0
  v_mov_b32 v4, 0
  v_mov_b32 v5, 0
  v_mov_b32 v6, 0
  v_mov_b32 v7, 0
  v_mov_b32 v8, 0
  v_mov_b32 v9, 0
  v_mov_b32 v10, 0
  v_mov_b32 v11, 0
  v_mov_b32 v12, 0
  v_mov_b32 v13, 0
  v_mov_b32 v14, 0
  v_mov_b32 v15, 0
  v_mov_b32 v16, 0
  v_mov_b32 v17, 0
  v_mov_b32 v18, 0
  v_mov_b32 v19, 0
  v_mov_b32 v20, 0
  v_mov_b32 v21, 0
  v_mov_b32 v22, 0
  v_mov_b32 v23, 0
  v_mov_b32 v24, 0
  v_mov_b32 v25, 0
  v_mov_b32 v26, 0
  v_mov_b32 v27, 0
  v_mov_b32 v28, 0
  v_mov_b32 v29, 0
  v_mov_b32 v30, 0
  v_mov_b32 v31, 0
  v_mov_b32 v32, 0
  v_mov_b32 v33, 0
  v_mov_b32 v34, 0
  v_mov_b32 v35, 0
  v_mov_b32 v36, 0
  v_mov_b32 v37, 0
  v_mov_b32 v38, 0
  v_mov_b32 v39, 0
  v_mov_b32 v40, 0
  v_mov_b32 v41, 0
  v_mov_b32 v42, 0
  v_mov_b32 v43, 0
  v_mov_b32 v44, 0
  v_mov_b32 v45, 0
  v_mov_b32 v46, 0
  v_mov_b32 v47, 0
  v_mov_b32 v48, 0
  v_mov_b32 v49, 0
  v_mov_b32 v50, 0
  v_mov_b32 v51, 0
  v_mov_b32 v52, 0
  v_mov_b32 v53, 0
  v_mov_b32 v54, 0
  v_mov_b32 v55, 0
  v_mov_b32 v56, 0
  v_mov_b32 v57, 0
  v_mov_b32 v58, 0
  v_mov_b32 v59, 0
  v_mov_b32 v60, 0
  v_mov_b32 v61, 0
  v_mov_b32 v62, 0
  v_mov_b32 v63, 0
  v_mov_b32 v64, 0
  v_mov_b32 v65, 0
  v_mov_b32 v66, 0
  v_mov_b32 v67, 0
  v_mov_b32 v68, 0
  v_mov_b32 v69, 0
  v_mov_b32 v70, 0
  v_mov_b32 v71, 0
  v_mov_b32 v72, 0
  v_mov_b32 v73, 0
  v_mov_b32 v74, 0
  v_mov_b32 v75, 0
  v_mov_b32 v76, 0
  v_mov_b32 v77, 0
  v_mov_b32 v78, 0
  v_mov_b32 v79, 0
  v_mov_b32 v80, 0
  v_mov_b32 v81, 0
  v_mov_b32 v82, 0
  v_mov_b32 v83, 0
  v_mov_b32 v84, 0
  v_mov_b32 v85, 0
  v_mov_b32 v86, 0
  v_mov_b32 v87, 0
  v_mov_b32 v88, 0
  v_mov_b32 v89, 0
  v_mov_b32 v90, 0
  v_mov_b32 v91, 0
  v_mov_b32 v92, 0
  v_mov_b32 v93, 0
  v_mov_b32 v94, 0
  v_mov_b32 v95, 0
  v_mov_b32 v96, 0
  v_mov_b32 v97, 0
  v_mov_b32 v98, 0
  v_mov_b32 v99, 0
  v_mov_b32 v100, 0
  v_mov_b32 v101, 0
  v_mov_b32 v102, 0
  v_mov_b32 v103, 0
  v_mov_b32 v104, 0
  v_mov_b32 v105, 0
  v_mov_b32 v106, 0
  v_mov_b32 v107, 0
  v_mov_b32 v156, 0
  v_mov_b32 v157, 0
  v_mov_b32 v158, 0
  v_mov_b32 v159, 0
  v_mov_b32 v160, 0
  v_mov_b32 v161, 0
  v_mov_b32 v162, 0
  v_mov_b32 v163, 0
  v_mov_b32 v164, 0
  v_mov_b32 v165, 0
  v_mov_b32 v166, 0
  v_mov_b32 v167, 0
  v_mov_b32 v192, 0x3f803f80
  v_mov_b32 v193, 0x3f803f80
  v_mov_b32 v194, 0x3f803f80
  v_mov_b32 v195, 0x3f803f80
  s_mov_b32 s28, 0xff800000
  s_mov_b32 s29, 0xff800000
  s_mov_b32 s30, 0xff800000
  s_mov_b32 s31, 0xff800000
  s_mov_b32 s26, 8
  s_waitcnt lgkmcnt(0)
  s_cmp_lt_u32 s2, 256
  s_cbranch_scc1 K1_NOPRIO2
  s_setprio 2
K1_NOPRIO2:
K1_LOOP:
  s_waitcnt vmcnt(8)
  s_barrier
  s_add_u32 m0, s27, 0xc000
  s_nop 0
  buffer_load_dwordx4 v240, s[4:7], s25 offen nt lds
  s_add_u32 m0, s27, 0xc400
  s_nop 0
  buffer_load_dwordx4 v241, s[4:7], s25 offen nt lds
  s_add_u32 m0, s27, 0xe000
  s_nop 0
  buffer_load_dwordx4 v242, s[8:11], s25 offen nt lds
  s_add_u32 m0, s27, 0xe400
  s_nop 0
  buffer_load_dwordx4 v243, s[8:11], s25 offen nt lds
  s_add_u32 s25, s25, 8192
  s_cmp_eq_u32 s24, 0
  s_cbranch_scc1 ST_0e
  ds_read_b128 v[196:199], v228 offset:0
  ds_read_b128 v[200:203], v228 offset:4096
  ds_read_b128 v[204:207], v229 offset:0
  ds_read_b128 v[208:211], v229 offset:4096
  ds_read_b128 v[212:215], v230 offset:0
  ds_read_b128 v[216:219], v230 offset:4096
  ds_read_b128 v[220:223], v231 offset:0
  ds_read_b128 v[224:227], v231 offset:4096
  s_waitcnt lgkmcnt(7)
  v_mfma_f32_16x16x32_bf16 v[168:171], v[196:199], v[108:111], v[156:159]
  v_mfma_f32_16x16x32_bf16 v[176:179], v[196:199], v[124:127], v[160:163]
  ds_read_b64_tr_b16 v[196:197], v232 offset:8192
  ds_read_b64_tr_b16 v[198:199], v232 offset:12288
  s_waitcnt lgkmcnt(8)
  v_mfma_f32_16x16x32_bf16 v[172:175], v[200:203], v[108:111], v[156:159]
  v_mfma_f32_16x16x32_bf16 v[180:183], v[200:203], v[124:127], v[160:163]
  ds_read_b64_tr_b16 v[200:201], v233 offset:8192
  ds_read_b64_tr_b16 v[202:203], v233 offset:12288
  s_waitcnt lgkmcnt(9)
  v_mfma_f32_16x16x32_bf16 v[168:171], v[204:207], v[112:115], v[168:171]
  v_mfma_f32_16x16x32_bf16 v[176:179], v[204:207], v[128:131], v[176:179]
  ds_read_b64_tr_b16 v[204:205], v234 offset:8192
  ds_read_b64_tr_b16 v[206:207], v234 offset:12288
  s_waitcnt lgkmcnt(10)
  v_mfma_f32_16x16x32_bf16 v[172:175], v[208:211], v[112:115], v[172:175]
  v_mfma_f32_16x16x32_bf16 v[180:183], v[208:211], v[128:131], v[180:183]
  ds_read_b64_tr_b16 v[208:209], v235 offset:8192
  ds_read_b64_tr_b16 v[210:211], v235 offset:12288
  s_waitcnt lgkmcnt(11)
  v_mfma_f32_16x16x32_bf16 v[168:171], v[212:215], v[116:119], v[168:171]
  v_mfma_f32_16x16x32_bf16 v[176:179], v[212:215], v[132:135], v[176:179]
  ds_read_b64_tr_b16 v[212:213], v236 offset:8192
  ds_read_b64_tr_b16 v[214:215], v236 offset:12288
  s_waitcnt lgkmcnt(12)
  v_mfma_f32_16x16x32_bf16 v[172:175], v[216:219], v[116:119], v[172:175]
  v_mfma_f32_16x16x32_bf16 v[180:183], v[216:219], v[132:135], v[180:183]
  ds_read_b64_tr_b16 v[216:217], v237 offset:8192
  ds_read_b64_tr_b16 v[218:219], v237 offset:12288
  s_waitcnt lgkmcnt(13)
  v_mfma_f32_16x16x32_bf16 v[168:171], v[220:223], v[120:123], v[168:171]
  v_mfma_f32_16x16x32_bf16 v[176:179], v[220:223], v[136:139], v[176:179]
  ds_read_b64_tr_b16 v[220:221], v238 offset:8192
  ds_read_b64_tr_b16 v[222:223], v238 offset:12288
  s_waitcnt lgkmcnt(14)
  v_mfma_f32_16x16x32_bf16 v[172:175], v[224:227], v[120:123], v[172:175]
  v_mfma_f32_16x16x32_bf16 v[180:183], v[224:227], v[136:139], v[180:183]
  ds_read_b64_tr_b16 v[224:225], v239 offset:8192
  ds_read_b64_tr_b16 v[226:227], v239 offset:12288
  s_nop 5
  v_max3_f32 v244, v168, v169, v170
  v_max3_f32 v245, v171, v172, v173
  v_max3_f32 v244, v244, v174, v175
  v_max3_f32 v245, v245, v176, v177
  v_max3_f32 v244, v244, v178, v179
  v_max3_f32 v245, v245, v180, v181
  v_max3_f32 v244, v244, v182, v183
  v_max_f32 v244, v244, v245
  v_cmp_lt_f32 vcc, s28, v244
  s_cbranch_vccnz SLOWM_0n
RETM_0n:
  v_exp_f32 v168, v168
  v_exp_f32 v169, v169
  v_exp_f32 v170, v170
  v_exp_f32 v171, v171
  v_exp_f32 v172, v172
  v_exp_f32 v173, v173
  v_exp_f32 v174, v174
  v_exp_f32 v175, v175
  v_exp_f32 v176, v176
  v_exp_f32 v177, v177
  v_exp_f32 v178, v178
  v_exp_f32 v179, v179
  v_exp_f32 v180, v180
  v_exp_f32 v181, v181
  v_exp_f32 v182, v182
  v_exp_f32 v183, v183
  v_cvt_pk_bf16_f32 v168, v168, v169
  v_cvt_pk_bf16_f32 v169, v170, v171
  v_cvt_pk_bf16_f32 v170, v172, v173
  v_cvt_pk_bf16_f32 v171, v174, v175
  v_cvt_pk_bf16_f32 v176, v176, v177
  v_cvt_pk_bf16_f32 v177, v178, v179
  v_cvt_pk_bf16_f32 v178, v180, v181
  v_cvt_pk_bf16_f32 v179, v182, v183
  s_nop 1
  v_mfma_f32_16x16x32_bf16 v[96:99], v[192:195], v[168:171], v[96:99]
  v_mfma_f32_16x16x32_bf16 v[100:103], v[192:195], v[176:179], v[100:103]
  s_waitcnt lgkmcnt(14)
  v_mfma_f32_16x16x32_bf16 v[0:3], v[196:199], v[168:171], v[0:3]
  v_mfma_f32_16x16x32_bf16 v[32:35], v[196:199], v[176:179], v[32:35]
  s_waitcnt lgkmcnt(12)
  v_mfma_f32_16x16x32_bf16 v[4:7], v[200:203], v[168:171], v[4:7]
  v_mfma_f32_16x16x32_bf16 v[36:39], v[200:203], v[176:179], v[36:39]
  s_waitcnt lgkmcnt(10)
  v_mfma_f32_16x16x32_bf16 v[8:11], v[204:207], v[168:171], v[8:11]
  v_mfma_f32_16x16x32_bf16 v[40:43], v[204:207], v[176:179], v[40:43]
  s_waitcnt lgkmcnt(8)
  v_mfma_f32_16x16x32_bf16 v[12:15], v[208:211], v[168:171], v[12:15]
  v_mfma_f32_16x16x32_bf16 v[44:47], v[208:211], v[176:179], v[44:47]
  s_waitcnt lgkmcnt(6)
  v_mfma_f32_16x16x32_bf16 v[16:19], v[212:215], v[168:171], v[16:19]
  v_mfma_f32_16x16x32_bf16 v[48:51], v[212:215], v[176:179], v[48:51]
  s_waitcnt lgkmcnt(4)
  v_mfma_f32_16x16x32_bf16 v[20:23], v[216:219], v[168:171], v[20:23]
  v_mfma_f32_16x16x32_bf16 v[52:55], v[216:219], v[176:179], v[52:55]
  s_waitcnt lgkmcnt(2)
  v_mfma_f32_16x16x32_bf16 v[24:27], v[220:223], v[168:171], v[24:27]
  v_mfma_f32_16x16x32_bf16 v[56:59], v[220:223], v[176:179], v[56:59]
  s_waitcnt lgkmcnt(0)
  v_mfma_f32_16x16x32_bf16 v[28:31], v[224:227], v[168:171], v[28:31]
  v_mfma_f32_16x16x32_bf16 v[60:63], v[224:227], v[176:179], v[60:63]
  s_branch ST_0_done
ST_0e:
  ds_read_b128 v[196:199], v228 offset:0
  ds_read_b128 v[200:203], v228 offset:4096
  ds_read_b128 v[204:207], v229 offset:0
  ds_read_b128 v[208:211], v229 offset:4096
  ds_read_b128 v[212:215], v230 offset:0
  ds_read_b128 v[216:219], v230 offset:4096
  ds_read_b128 v[220:223], v231 offset:0
  ds_read_b128 v[224:227], v231 offset:4096
  s_waitcnt lgkmcnt(7)
  v_mfma_f32_16x16x32_bf16 v[168:171], v[196:199], v[108:111], v[156:159]
  v_mfma_f32_16x16x32_bf16 v[176:179], v[196:199], v[124:127], v[160:163]
  v_mfma_f32_16x16x32_bf16 v[184:187], v[196:199], v[140:143], v[164:167]
  ds_read_b64_tr_b16 v[196:197], v232 offset:8192
  ds_read_b64_tr_b16 v[198:199], v232 offset:12288
  s_waitcnt lgkmcnt(8)
  v_mfma_f32_16x16x32_bf16 v[172:175], v[200:203], v[108:111], v[156:159]
  v_mfma_f32_16x16x32_bf16 v[180:183], v[200:203], v[124:127], v[160:163]
  v_mfma_f32_16x16x32_bf16 v[188:191], v[200:203], v[140:143], v[164:167]
  ds_read_b64_tr_b16 v[200:201], v233 offset:8192
  ds_read_b64_tr_b16 v[202:203], v233 offset:12288
  s_waitcnt lgkmcnt(9)
  v_mfma_f32_16x16x32_bf16 v[168:171], v[204:207], v[112:115], v[168:171]
  v_mfma_f32_16x16x32_bf16 v[176:179], v[204:207], v[128:131], v[176:179]
  v_mfma_f32_16x16x32_bf16 v[184:187], v[204:207], v[144:147], v[184:187]
  ds_read_b64_tr_b16 v[204:205], v234 offset:8192
  ds_read_b64_tr_b16 v[206:207], v234 offset:12288
  s_waitcnt lgkmcnt(10)
  v_mfma_f32_16x16x32_bf16 v[172:175], v[208:211], v[112:115], v[172:175]
  v_mfma_f32_16x16x32_bf16 v[180:183], v[208:211], v[128:131], v[180:183]
  v_mfma_f32_16x16x32_bf16 v[188:191], v[208:211], v[144:147], v[188:191]
  ds_read_b64_tr_b16 v[208:209], v235 offset:8192
  ds_read_b64_tr_b16 v[210:211], v235 offset:12288
  s_waitcnt lgkmcnt(11)
  v_mfma_f32_16x16x32_bf16 v[168:171], v[212:215], v[116:119], v[168:171]
  v_mfma_f32_16x16x32_bf16 v[176:179], v[212:215], v[132:135], v[176:179]
  v_mfma_f32_16x16x32_bf16 v[184:187], v[212:215], v[148:151], v[184:187]
  ds_read_b64_tr_b16 v[212:213], v236 offset:8192
  ds_read_b64_tr_b16 v[214:215], v236 offset:12288
  s_waitcnt lgkmcnt(12)
  v_mfma_f32_16x16x32_bf16 v[172:175], v[216:219], v[116:119], v[172:175]
  v_mfma_f32_16x16x32_bf16 v[180:183], v[216:219], v[132:135], v[180:183]
  v_mfma_f32_16x16x32_bf16 v[188:191], v[216:219], v[148:151], v[188:191]
  ds_read_b64_tr_b16 v[216:217], v237 offset:8192
  ds_read_b64_tr_b16 v[218:219], v237 offset:12288
  s_waitcnt lgkmcnt(13)
  v_mfma_f32_16x16x32_bf16 v[168:171], v[220:223], v[120:123], v[168:171]
  v_mfma_f32_16x16x32_bf16 v[176:179], v[220:223], v[136:139], v[176:179]
  v_mfma_f32_16x16x32_bf16 v[184:187], v[220:223], v[152:155], v[184:187]
  ds_read_b64_tr_b16 v[220:221], v238 offset:8192
  ds_read_b64_tr_b16 v[222:223], v238 offset:12288
  s_waitcnt lgkmcnt(14)
  v_mfma_f32_16x16x32_bf16 v[172:175], v[224:227], v[120:123], v[172:175]
  v_mfma_f32_16x16x32_bf16 v[180:183], v[224:227], v[136:139], v[180:183]
  v_mfma_f32_16x16x32_bf16 v[188:191], v[224:227], v[152:155], v[188:191]
  ds_read_b64_tr_b16 v[224:225], v239 offset:8192
  ds_read_b64_tr_b16 v[226:227], v239 offset:12288
  s_nop 5
  v_max3_f32 v244, v168, v169, v170
  v_max3_f32 v245, v171, v172, v173
  v_max3_f32 v244, v244, v174, v175
  v_max3_f32 v245, v245, v176, v177
  v_max3_f32 v244, v244, v178, v179
  v_max3_f32 v245, v245, v180, v181
  v_max3_f32 v244, v244, v182, v183
  v_max_f32 v244, v244, v245
  v_cmp_lt_f32 vcc, s28, v244
  s_cbranch_vccnz SLOWM_0e
RETM_0e:
  v_max3_f32 v244, v184, v185, v186
  v_max3_f32 v245, v187, v188, v189
  v_max3_f32 v244, v244, v190, v191
  v_max_f32 v244, v244, v245
  v_cmp_lt_f32 vcc, s30, v244
  s_cbranch_vccnz SLOWE_0e
RETE_0e:
  v_exp_f32 v168, v168
  v_exp_f32 v169, v169
  v_exp_f32 v170, v170
  v_exp_f32 v171, v171
  v_exp_f32 v172, v172
  v_exp_f32 v173, v173
  v_exp_f32 v174, v174
  v_exp_f32 v175, v175
  v_exp_f32 v176, v176
  v_exp_f32 v177, v177
  v_exp_f32 v178, v178
  v_exp_f32 v179, v179
  v_exp_f32 v180, v180
  v_exp_f32 v181, v181
  v_exp_f32 v182, v182
  v_exp_f32 v183, v183
  v_exp_f32 v184, v184
  v_exp_f32 v185, v185
  v_exp_f32 v186, v186
  v_exp_f32 v187, v187
  v_exp_f32 v188, v188
  v_exp_f32 v189, v189
  v_exp_f32 v190, v190
  v_exp_f32 v191, v191
  v_cvt_pk_bf16_f32 v168, v168, v169
  v_cvt_pk_bf16_f32 v169, v170, v171
  v_cvt_pk_bf16_f32 v170, v172, v173
  v_cvt_pk_bf16_f32 v171, v174, v175
  v_cvt_pk_bf16_f32 v176, v176, v177
  v_cvt_pk_bf16_f32 v177, v178, v179
  v_cvt_pk_bf16_f32 v178, v180, v181
  v_cvt_pk_bf16_f32 v179, v182, v183
  v_cvt_pk_bf16_f32 v184, v184, v185
  v_cvt_pk_bf16_f32 v185, v186, v187
  v_cvt_pk_bf16_f32 v186, v188, v189
  v_cvt_pk_bf16_f32 v187, v190, v191
  s_nop 1
  v_mfma_f32_16x16x32_bf16 v[96:99], v[192:195], v[168:171], v[96:99]
  v_mfma_f32_16x16x32_bf16 v[100:103], v[192:195], v[176:179], v[100:103]
  v_mfma_f32_16x16x32_bf16 v[104:107], v[192:195], v[184:187], v[104:107]
  s_waitcnt lgkmcnt(14)
  v_mfma_f32_16x16x32_bf16 v[0:3], v[196:199], v[168:171], v[0:3]
  v_mfma_f32_16x16x32_bf16 v[32:35], v[196:199], v[176:179], v[32:35]
  v_mfma_f32_16x16x32_bf16 v[64:67], v[196:199], v[184:187], v[64:67]
  s_waitcnt lgkmcnt(12)
  v_mfma_f32_16x16x32_bf16 v[4:7], v[200:203], v[168:171], v[4:7]
  v_mfma_f32_16x16x32_bf16 v[36:39], v[200:203], v[176:179], v[36:39]
  v_mfma_f32_16x16x32_bf16 v[68:71], v[200:203], v[184:187], v[68:71]
  s_waitcnt lgkmcnt(10)
  v_mfma_f32_16x16x32_bf16 v[8:11], v[204:207], v[168:171], v[8:11]
  v_mfma_f32_16x16x32_bf16 v[40:43], v[204:207], v[176:179], v[40:43]
  v_mfma_f32_16x16x32_bf16 v[72:75], v[204:207], v[184:187], v[72:75]
  s_waitcnt lgkmcnt(8)
  v_mfma_f32_16x16x32_bf16 v[12:15], v[208:211], v[168:171], v[12:15]
  v_mfma_f32_16x16x32_bf16 v[44:47], v[208:211], v[176:179], v[44:47]
  v_mfma_f32_16x16x32_bf16 v[76:79], v[208:211], v[184:187], v[76:79]
  s_waitcnt lgkmcnt(6)
  v_mfma_f32_16x16x32_bf16 v[16:19], v[212:215], v[168:171], v[16:19]
  v_mfma_f32_16x16x32_bf16 v[48:51], v[212:215], v[176:179], v[48:51]
  v_mfma_f32_16x16x32_bf16 v[80:83], v[212:215], v[184:187], v[80:83]
  s_waitcnt lgkmcnt(4)
  v_mfma_f32_16x16x32_bf16 v[20:23], v[216:219], v[168:171], v[20:23]
  v_mfma_f32_16x16x32_bf16 v[52:55], v[216:219], v[176:179], v[52:55]
  v_mfma_f32_16x16x32_bf16 v[84:87], v[216:219], v[184:187], v[84:87]
  s_waitcnt lgkmcnt(2)
  v_mfma_f32_16x16x32_bf16 v[24:27], v[220:223], v[168:171], v[24:27]
  v_mfma_f32_16x16x32_bf16 v[56:59], v[220:223], v[176:179], v[56:59]
  v_mfma_f32_16x16x32_bf16 v[88:91], v[220:223], v[184:187], v[88:91]
  s_waitcnt lgkmcnt(0)
  v_mfma_f32_16x16x32_bf16 v[28:31], v[224:227], v[168:171], v[28:31]
  v_mfma_f32_16x16x32_bf16 v[60:63], v[224:227], v[176:179], v[60:63]
  v_mfma_f32_16x16x32_bf16 v[92:95], v[224:227], v[184:187], v[92:95]
ST_0_done:
  s_waitcnt vmcnt(8)
  s_barrier
  s_add_u32 m0, s27, 0x0
  s_nop 0
  buffer_load_dwordx4 v240, s[4:7], s25 offen nt lds
  s_add_u32 m0, s27, 0x400
  s_nop 0
  buffer_load_dwordx4 v241, s[4:7], s25 offen nt lds
  s_add_u32 m0, s27, 0x2000
  s_nop 0
  buffer_load_dwordx4 v242, s[8:11], s25 offen nt lds
  s_add_u32 m0, s27, 0x2400
  s_nop 0
  buffer_load_dwordx4 v243, s[8:11], s25 offen nt lds
  s_add_u32 s25, s25, 8192
  s_cmp_eq_u32 s24, 1
  s_cbranch_scc1 ST_1e
  ds_read_b128 v[196:199], v228 offset:32768
  ds_read_b128 v[200:203], v228 offset:36864
  ds_read_b128 v[204:207], v229 offset:32768
  ds_read_b128 v[208:211], v229 offset:36864
  ds_read_b128 v[212:215], v230 offset:32768
  ds_read_b128 v[216:219], v230 offset:36864
  ds_read_b128 v[220:223], v231 offset:32768
  ds_read_b128 v[224:227], v231 offset:36864
  s_waitcnt lgkmcnt(7)
  v_mfma_f32_16x16x32_bf16 v[168:171], v[196:199], v[108:111], v[156:159]
  v_mfma_f32_16x16x32_bf16 v[176:179], v[196:199], v[124:127], v[160:163]
  ds_read_b64_tr_b16 v[196:197], v232 offset:40960
  ds_read_b64_tr_b16 v[198:199], v232 offset:45056
  s_waitcnt lgkmcnt(8)
  v_mfma_f32_16x16x32_bf16 v[172:175], v[200:203], v[108:111], v[156:159]
  v_mfma_f32_16x16x32_bf16 v[180:183], v[200:203], v[124:127], v[160:163]
  ds_read_b64_tr_b16 v[200:201], v233 offset:40960
  ds_read_b64_tr_b16 v[202:203], v233 offset:45056
  s_waitcnt lgkmcnt(9)
  v_mfma_f32_16x16x32_bf16 v[168:171], v[204:207], v[112:115], v[168:171]
  v_mfma_f32_16x16x32_bf16 v[176:179], v[204:207], v[128:131], v[176:179]
  ds_read_b64_tr_b16 v[204:205], v234 offset:40960
  ds_read_b64_tr_b16 v[206:207], v234 offset:45056
  s_waitcnt lgkmcnt(10)
  v_mfma_f32_16x16x32_bf16 v[172:175], v[208:211], v[112:115], v[172:175]
  v_mfma_f32_16x16x32_bf16 v[180:183], v[208:211], v[128:131], v[180:183]
  ds_read_b64_tr_b16 v[208:209], v235 offset:40960
  ds_read_b64_tr_b16 v[210:211], v235 offset:45056
  s_waitcnt lgkmcnt(11)
  v_mfma_f32_16x16x32_bf16 v[168:171], v[212:215], v[116:119], v[168:171]
  v_mfma_f32_16x16x32_bf16 v[176:179], v[212:215], v[132:135], v[176:179]
  ds_read_b64_tr_b16 v[212:213], v236 offset:40960
  ds_read_b64_tr_b16 v[214:215], v236 offset:45056
  s_waitcnt lgkmcnt(12)
  v_mfma_f32_16x16x32_bf16 v[172:175], v[216:219], v[116:119], v[172:175]
  v_mfma_f32_16x16x32_bf16 v[180:183], v[216:219], v[132:135], v[180:183]
  ds_read_b64_tr_b16 v[216:217], v237 offset:40960
  ds_read_b64_tr_b16 v[218:219], v237 offset:45056
  s_waitcnt lgkmcnt(13)
  v_mfma_f32_16x16x32_bf16 v[168:171], v[220:223], v[120:123], v[168:171]
  v_mfma_f32_16x16x32_bf16 v[176:179], v[220:223], v[136:139], v[176:179]
  ds_read_b64_tr_b16 v[220:221], v238 offset:40960
  ds_read_b64_tr_b16 v[222:223], v238 offset:45056
  s_waitcnt lgkmcnt(14)
  v_mfma_f32_16x16x32_bf16 v[172:175], v[224:227], v[120:123], v[172:175]
  v_mfma_f32_16x16x32_bf16 v[180:183], v[224:227], v[136:139], v[180:183]
  ds_read_b64_tr_b16 v[224:225], v239 offset:40960
  ds_read_b64_tr_b16 v[226:227], v239 offset:45056
  s_nop 5
  v_max3_f32 v244, v168, v169, v170
  v_max3_f32 v245, v171, v172, v173
  v_max3_f32 v244, v244, v174, v175
  v_max3_f32 v245, v245, v176, v177
  v_max3_f32 v244, v244, v178, v179
  v_max3_f32 v245, v245, v180, v181
  v_max3_f32 v244, v244, v182, v183
  v_max_f32 v244, v244, v245
  v_cmp_lt_f32 vcc, s28, v244
  s_cbranch_vccnz SLOWM_1n
RETM_1n:
  v_exp_f32 v168, v168
  v_exp_f32 v169, v169
  v_exp_f32 v170, v170
  v_exp_f32 v171, v171
  v_exp_f32 v172, v172
  v_exp_f32 v173, v173
  v_exp_f32 v174, v174
  v_exp_f32 v175, v175
  v_exp_f32 v176, v176
  v_exp_f32 v177, v177
  v_exp_f32 v178, v178
  v_exp_f32 v179, v179
  v_exp_f32 v180, v180
  v_exp_f32 v181, v181
  v_exp_f32 v182, v182
  v_exp_f32 v183, v183
  v_cvt_pk_bf16_f32 v168, v168, v169
  v_cvt_pk_bf16_f32 v169, v170, v171
  v_cvt_pk_bf16_f32 v170, v172, v173
  v_cvt_pk_bf16_f32 v171, v174, v175
  v_cvt_pk_bf16_f32 v176, v176, v177
  v_cvt_pk_bf16_f32 v177, v178, v179
  v_cvt_pk_bf16_f32 v178, v180, v181
  v_cvt_pk_bf16_f32 v179, v182, v183
  s_nop 1
  v_mfma_f32_16x16x32_bf16 v[96:99], v[192:195], v[168:171], v[96:99]
  v_mfma_f32_16x16x32_bf16 v[100:103], v[192:195], v[176:179], v[100:103]
  s_waitcnt lgkmcnt(14)
  v_mfma_f32_16x16x32_bf16 v[0:3], v[196:199], v[168:171], v[0:3]
  v_mfma_f32_16x16x32_bf16 v[32:35], v[196:199], v[176:179], v[32:35]
  s_waitcnt lgkmcnt(12)
  v_mfma_f32_16x16x32_bf16 v[4:7], v[200:203], v[168:171], v[4:7]
  v_mfma_f32_16x16x32_bf16 v[36:39], v[200:203], v[176:179], v[36:39]
  s_waitcnt lgkmcnt(10)
  v_mfma_f32_16x16x32_bf16 v[8:11], v[204:207], v[168:171], v[8:11]
  v_mfma_f32_16x16x32_bf16 v[40:43], v[204:207], v[176:179], v[40:43]
  s_waitcnt lgkmcnt(8)
  v_mfma_f32_16x16x32_bf16 v[12:15], v[208:211], v[168:171], v[12:15]
  v_mfma_f32_16x16x32_bf16 v[44:47], v[208:211], v[176:179], v[44:47]
  s_waitcnt lgkmcnt(6)
  v_mfma_f32_16x16x32_bf16 v[16:19], v[212:215], v[168:171], v[16:19]
  v_mfma_f32_16x16x32_bf16 v[48:51], v[212:215], v[176:179], v[48:51]
  s_waitcnt lgkmcnt(4)
  v_mfma_f32_16x16x32_bf16 v[20:23], v[216:219], v[168:171], v[20:23]
  v_mfma_f32_16x16x32_bf16 v[52:55], v[216:219], v[176:179], v[52:55]
  s_waitcnt lgkmcnt(2)
  v_mfma_f32_16x16x32_bf16 v[24:27], v[220:223], v[168:171], v[24:27]
  v_mfma_f32_16x16x32_bf16 v[56:59], v[220:223], v[176:179], v[56:59]
  s_waitcnt lgkmcnt(0)
  v_mfma_f32_16x16x32_bf16 v[28:31], v[224:227], v[168:171], v[28:31]
  v_mfma_f32_16x16x32_bf16 v[60:63], v[224:227], v[176:179], v[60:63]
  s_branch ST_1_done
ST_1e:
  ds_read_b128 v[196:199], v228 offset:32768
  ds_read_b128 v[200:203], v228 offset:36864
  ds_read_b128 v[204:207], v229 offset:32768
  ds_read_b128 v[208:211], v229 offset:36864
  ds_read_b128 v[212:215], v230 offset:32768
  ds_read_b128 v[216:219], v230 offset:36864
  ds_read_b128 v[220:223], v231 offset:32768
  ds_read_b128 v[224:227], v231 offset:36864
  s_waitcnt lgkmcnt(7)
  v_mfma_f32_16x16x32_bf16 v[168:171], v[196:199], v[108:111], v[156:159]
  v_mfma_f32_16x16x32_bf16 v[176:179], v[196:199], v[124:127], v[160:163]
  v_mfma_f32_16x16x32_bf16 v[184:187], v[196:199], v[140:143], v[164:167]
  ds_read_b64_tr_b16 v[196:197], v232 offset:40960
  ds_read_b64_tr_b16 v[198:199], v232 offset:45056
  s_waitcnt lgkmcnt(8)
  v_mfma_f32_16x16x32_bf16 v[172:175], v[200:203], v[108:111], v[156:159]
  v_mfma_f32_16x16x32_bf16 v[180:183], v[200:203], v[124:127], v[160:163]
  v_mfma_f32_16x16x32_bf16 v[188:191], v[200:203], v[140:143], v[164:167]
  ds_read_b64_tr_b16 v[200:201], v233 offset:40960
  ds_read_b64_tr_b16 v[202:203], v233 offset:45056
  s_waitcnt lgkmcnt(9)
  v_mfma_f32_16x16x32_bf16 v[168:171], v[204:207], v[112:115], v[168:171]
  v_mfma_f32_16x16x32_bf16 v[176:179], v[204:207], v[128:131], v[176:179]
  v_mfma_f32_16x16x32_bf16 v[184:187], v[204:207], v[144:147], v[184:187]
  ds_read_b64_tr_b16 v[204:205], v234 offset:40960
  ds_read_b64_tr_b16 v[206:207], v234 offset:45056
  s_waitcnt lgkmcnt(10)
  v_mfma_f32_16x16x32_bf16 v[172:175], v[208:211], v[112:115], v[172:175]
  v_mfma_f32_16x16x32_bf16 v[180:183], v[208:211], v[128:131], v[180:183]
  v_mfma_f32_16x16x32_bf16 v[188:191], v[208:211], v[144:147], v[188:191]
  ds_read_b64_tr_b16 v[208:209], v235 offset:40960
  ds_read_b64_tr_b16 v[210:211], v235 offset:45056
  s_waitcnt lgkmcnt(11)
  v_mfma_f32_16x16x32_bf16 v[168:171], v[212:215], v[116:119], v[168:171]
  v_mfma_f32_16x16x32_bf16 v[176:179], v[212:215], v[132:135], v[176:179]
  v_mfma_f32_16x16x32_bf16 v[184:187], v[212:215], v[148:151], v[184:187]
  ds_read_b64_tr_b16 v[212:213], v236 offset:40960
  ds_read_b64_tr_b16 v[214:215], v236 offset:45056
  s_waitcnt lgkmcnt(12)
  v_mfma_f32_16x16x32_bf16 v[172:175], v[216:219], v[116:119], v[172:175]
  v_mfma_f32_16x16x32_bf16 v[180:183], v[216:219], v[132:135], v[180:183]
  v_mfma_f32_16x16x32_bf16 v[188:191], v[216:219], v[148:151], v[188:191]
  ds_read_b64_tr_b16 v[216:217], v237 offset:40960
  ds_read_b64_tr_b16 v[218:219], v237 offset:45056
  s_waitcnt lgkmcnt(13)
  v_mfma_f32_16x16x32_bf16 v[168:171], v[220:223], v[120:123], v[168:171]
  v_mfma_f32_16x16x32_bf16 v[176:179], v[220:223], v[136:139], v[176:179]
  v_mfma_f32_16x16x32_bf16 v[184:187], v[220:223], v[152:155], v[184:187]
  ds_read_b64_tr_b16 v[220:221], v238 offset:40960
  ds_read_b64_tr_b16 v[222:223], v238 offset:45056
  s_waitcnt lgkmcnt(14)
  v_mfma_f32_16x16x32_bf16 v[172:175], v[224:227], v[120:123], v[172:175]
  v_mfma_f32_16x16x32_bf16 v[180:183], v[224:227], v[136:139], v[180:183]
  v_mfma_f32_16x16x32_bf16 v[188:191], v[224:227], v[152:155], v[188:191]
  ds_read_b64_tr_b16 v[224:225], v239 offset:40960
  ds_read_b64_tr_b16 v[226:227], v239 offset:45056
  s_nop 5
  v_max3_f32 v244, v168, v169, v170
  v_max3_f32 v245, v171, v172, v173
  v_max3_f32 v244, v244, v174, v175
  v_max3_f32 v245, v245, v176, v177
  v_max3_f32 v244, v244, v178, v179
  v_max3_f32 v245, v245, v180, v181
  v_max3_f32 v244, v244, v182, v183
  v_max_f32 v244, v244, v245
  v_cmp_lt_f32 vcc, s28, v244
  s_cbranch_vccnz SLOWM_1e
RETM_1e:
  v_max3_f32 v244, v184, v185, v186
  v_max3_f32 v245, v187, v188, v189
  v_max3_f32 v244, v244, v190, v191
  v_max_f32 v244, v244, v245
  v_cmp_lt_f32 vcc, s30, v244
  s_cbranch_vccnz SLOWE_1e
RETE_1e:
  v_exp_f32 v168, v168
  v_exp_f32 v169, v169
  v_exp_f32 v170, v170
  v_exp_f32 v171, v171
  v_exp_f32 v172, v172
  v_exp_f32 v173, v173
  v_exp_f32 v174, v174
  v_exp_f32 v175, v175
  v_exp_f32 v176, v176
  v_exp_f32 v177, v177
  v_exp_f32 v178, v178
  v_exp_f32 v179, v179
  v_exp_f32 v180, v180
  v_exp_f32 v181, v181
  v_exp_f32 v182, v182
  v_exp_f32 v183, v183
  v_exp_f32 v184, v184
  v_exp_f32 v185, v185
  v_exp_f32 v186, v186
  v_exp_f32 v187, v187
  v_exp_f32 v188, v188
  v_exp_f32 v189, v189
  v_exp_f32 v190, v190
  v_exp_f32 v191, v191
  v_cvt_pk_bf16_f32 v168, v168, v169
  v_cvt_pk_bf16_f32 v169, v170, v171
  v_cvt_pk_bf16_f32 v170, v172, v173
  v_cvt_pk_bf16_f32 v171, v174, v175
  v_cvt_pk_bf16_f32 v176, v176, v177
  v_cvt_pk_bf16_f32 v177, v178, v179
  v_cvt_pk_bf16_f32 v178, v180, v181
  v_cvt_pk_bf16_f32 v179, v182, v183
  v_cvt_pk_bf16_f32 v184, v184, v185
  v_cvt_pk_bf16_f32 v185, v186, v187
  v_cvt_pk_bf16_f32 v186, v188, v189
  v_cvt_pk_bf16_f32 v187, v190, v191
  s_nop 1
  v_mfma_f32_16x16x32_bf16 v[96:99], v[192:195], v[168:171], v[96:99]
  v_mfma_f32_16x16x32_bf16 v[100:103], v[192:195], v[176:179], v[100:103]
  v_mfma_f32_16x16x32_bf16 v[104:107], v[192:195], v[184:187], v[104:107]
  s_waitcnt lgkmcnt(14)
  v_mfma_f32_16x16x32_bf16 v[0:3], v[196:199], v[168:171], v[0:3]
  v_mfma_f32_16x16x32_bf16 v[32:35], v[196:199], v[176:179], v[32:35]
  v_mfma_f32_16x16x32_bf16 v[64:67], v[196:199], v[184:187], v[64:67]
  s_waitcnt lgkmcnt(12)
  v_mfma_f32_16x16x32_bf16 v[4:7], v[200:203], v[168:171], v[4:7]
  v_mfma_f32_16x16x32_bf16 v[36:39], v[200:203], v[176:179], v[36:39]
  v_mfma_f32_16x16x32_bf16 v[68:71], v[200:203], v[184:187], v[68:71]
  s_waitcnt lgkmcnt(10)
  v_mfma_f32_16x16x32_bf16 v[8:11], v[204:207], v[168:171], v[8:11]
  v_mfma_f32_16x16x32_bf16 v[40:43], v[204:207], v[176:179], v[40:43]
  v_mfma_f32_16x16x32_bf16 v[72:75], v[204:207], v[184:187], v[72:75]
  s_waitcnt lgkmcnt(8)
  v_mfma_f32_16x16x32_bf16 v[12:15], v[208:211], v[168:171], v[12:15]
  v_mfma_f32_16x16x32_bf16 v[44:47], v[208:211], v[176:179], v[44:47]
  v_mfma_f32_16x16x32_bf16 v[76:79], v[208:211], v[184:187], v[76:79]
  s_waitcnt lgkmcnt(6)
  v_mfma_f32_16x16x32_bf16 v[16:19], v[212:215], v[168:171], v[16:19]
  v_mfma_f32_16x16x32_bf16 v[48:51], v[212:215], v[176:179], v[48:51]
  v_mfma_f32_16x16x32_bf16 v[80:83], v[212:215], v[184:187], v[80:83]
  s_waitcnt lgkmcnt(4)
  v_mfma_f32_16x16x32_bf16 v[20:23], v[216:219], v[168:171], v[20:23]
  v_mfma_f32_16x16x32_bf16 v[52:55], v[216:219], v[176:179], v[52:55]
  v_mfma_f32_16x16x32_bf16 v[84:87], v[216:219], v[184:187], v[84:87]
  s_waitcnt lgkmcnt(2)
  v_mfma_f32_16x16x32_bf16 v[24:27], v[220:223], v[168:171], v[24:27]
  v_mfma_f32_16x16x32_bf16 v[56:59], v[220:223], v[176:179], v[56:59]
  v_mfma_f32_16x16x32_bf16 v[88:91], v[220:223], v[184:187], v[88:91]
  s_waitcnt lgkmcnt(0)
  v_mfma_f32_16x16x32_bf16 v[28:31], v[224:227], v[168:171], v[28:31]
  v_mfma_f32_16x16x32_bf16 v[60:63], v[224:227], v[176:179], v[60:63]
  v_mfma_f32_16x16x32_bf16 v[92:95], v[224:227], v[184:187], v[92:95]
ST_1_done:
  s_waitcnt vmcnt(8)
  s_barrier
  s_add_u32 m0, s27, 0x8000
  s_nop 0
  buffer_load_dwordx4 v240, s[4:7], s25 offen nt lds
  s_add_u32 m0, s27, 0x8400
  s_nop 0
  buffer_load_dwordx4 v241, s[4:7], s25 offen nt lds
  s_add_u32 m0, s27, 0xa000
  s_nop 0
  buffer_load_dwordx4 v242, s[8:11], s25 offen nt lds
  s_add_u32 m0, s27, 0xa400
  s_nop 0
  buffer_load_dwordx4 v243, s[8:11], s25 offen nt lds
  s_add_u32 s25, s25, 8192
  s_cmp_eq_u32 s24, 2
  s_cbranch_scc1 ST_2e
  ds_read_b128 v[196:199], v228 offset:16384
  ds_read_b128 v[200:203], v228 offset:20480
  ds_read_b128 v[204:207], v229 offset:16384
  ds_read_b128 v[208:211], v229 offset:20480
  ds_read_b128 v[212:215], v230 offset:16384
  ds_read_b128 v[216:219], v230 offset:20480
  ds_read_b128 v[220:223], v231 offset:16384
  ds_read_b128 v[224:227], v231 offset:20480
  s_waitcnt lgkmcnt(7)
  v_mfma_f32_16x16x32_bf16 v[168:171], v[196:199], v[108:111], v[156:159]
  v_mfma_f32_16x16x32_bf16 v[176:179], v[196:199], v[124:127], v[160:163]
  ds_read_b64_tr_b16 v[196:197], v232 offset:24576
  ds_read_b64_tr_b16 v[198:199], v232 offset:28672
  s_waitcnt lgkmcnt(8)
  v_mfma_f32_16x16x32_bf16 v[172:175], v[200:203], v[108:111], v[156:159]
  v_mfma_f32_16x16x32_bf16 v[180:183], v[200:203], v[124:127], v[160:163]
  ds_read_b64_tr_b16 v[200:201], v233 offset:24576
  ds_read_b64_tr_b16 v[202:203], v233 offset:28672
  s_waitcnt lgkmcnt(9)
  v_mfma_f32_16x16x32_bf16 v[168:171], v[204:207], v[112:115], v[168:171]
  v_mfma_f32_16x16x32_bf16 v[176:179], v[204:207], v[128:131], v[176:179]
  ds_read_b64_tr_b16 v[204:205], v234 offset:24576
  ds_read_b64_tr_b16 v[206:207], v234 offset:28672
  s_waitcnt lgkmcnt(10)
  v_mfma_f32_16x16x32_bf16 v[172:175], v[208:211], v[112:115], v[172:175]
  v_mfma_f32_16x16x32_bf16 v[180:183], v[208:211], v[128:131], v[180:183]
  ds_read_b64_tr_b16 v[208:209], v235 offset:24576
  ds_read_b64_tr_b16 v[210:211], v235 offset:28672
  s_waitcnt lgkmcnt(11)
  v_mfma_f32_16x16x32_bf16 v[168:171], v[212:215], v[116:119], v[168:171]
  v_mfma_f32_16x16x32_bf16 v[176:179], v[212:215], v[132:135], v[176:179]
  ds_read_b64_tr_b16 v[212:213], v236 offset:24576
  ds_read_b64_tr_b16 v[214:215], v236 offset:28672
  s_waitcnt lgkmcnt(12)
  v_mfma_f32_16x16x32_bf16 v[172:175], v[216:219], v[116:119], v[172:175]
  v_mfma_f32_16x16x32_bf16 v[180:183], v[216:219], v[132:135], v[180:183]
  ds_read_b64_tr_b16 v[216:217], v237 offset:24576
  ds_read_b64_tr_b16 v[218:219], v237 offset:28672
  s_waitcnt lgkmcnt(13)
  v_mfma_f32_16x16x32_bf16 v[168:171], v[220:223], v[120:123], v[168:171]
  v_mfma_f32_16x16x32_bf16 v[176:179], v[220:223], v[136:139], v[176:179]
  ds_read_b64_tr_b16 v[220:221], v238 offset:24576
  ds_read_b64_tr_b16 v[222:223], v238 offset:28672
  s_waitcnt lgkmcnt(14)
  v_mfma_f32_16x16x32_bf16 v[172:175], v[224:227], v[120:123], v[172:175]
  v_mfma_f32_16x16x32_bf16 v[180:183], v[224:227], v[136:139], v[180:183]
  ds_read_b64_tr_b16 v[224:225], v239 offset:24576
  ds_read_b64_tr_b16 v[226:227], v239 offset:28672
  s_nop 5
  v_max3_f32 v244, v168, v169, v170
  v_max3_f32 v245, v171, v172, v173
  v_max3_f32 v244, v244, v174, v175
  v_max3_f32 v245, v245, v176, v177
  v_max3_f32 v244, v244, v178, v179
  v_max3_f32 v245, v245, v180, v181
  v_max3_f32 v244, v244, v182, v183
  v_max_f32 v244, v244, v245
  v_cmp_lt_f32 vcc, s28, v244
  s_cbranch_vccnz SLOWM_2n
RETM_2n:
  v_exp_f32 v168, v168
  v_exp_f32 v169, v169
  v_exp_f32 v170, v170
  v_exp_f32 v171, v171
  v_exp_f32 v172, v172
  v_exp_f32 v173, v173
  v_exp_f32 v174, v174
  v_exp_f32 v175, v175
  v_exp_f32 v176, v176
  v_exp_f32 v177, v177
  v_exp_f32 v178, v178
  v_exp_f32 v179, v179
  v_exp_f32 v180, v180
  v_exp_f32 v181, v181
  v_exp_f32 v182, v182
  v_exp_f32 v183, v183
  v_cvt_pk_bf16_f32 v168, v168, v169
  v_cvt_pk_bf16_f32 v169, v170, v171
  v_cvt_pk_bf16_f32 v170, v172, v173
  v_cvt_pk_bf16_f32 v171, v174, v175
  v_cvt_pk_bf16_f32 v176, v176, v177
  v_cvt_pk_bf16_f32 v177, v178, v179
  v_cvt_pk_bf16_f32 v178, v180, v181
  v_cvt_pk_bf16_f32 v179, v182, v183
  s_nop 1
  v_mfma_f32_16x16x32_bf16 v[96:99], v[192:195], v[168:171], v[96:99]
  v_mfma_f32_16x16x32_bf16 v[100:103], v[192:195], v[176:179], v[100:103]
  s_waitcnt lgkmcnt(14)
  v_mfma_f32_16x16x32_bf16 v[0:3], v[196:199], v[168:171], v[0:3]
  v_mfma_f32_16x16x32_bf16 v[32:35], v[196:199], v[176:179], v[32:35]
  s_waitcnt lgkmcnt(12)
  v_mfma_f32_16x16x32_bf16 v[4:7], v[200:203], v[168:171], v[4:7]
  v_mfma_f32_16x16x32_bf16 v[36:39], v[200:203], v[176:179], v[36:39]
  s_waitcnt lgkmcnt(10)
  v_mfma_f32_16x16x32_bf16 v[8:11], v[204:207], v[168:171], v[8:11]
  v_mfma_f32_16x16x32_bf16 v[40:43], v[204:207], v[176:179], v[40:43]
  s_waitcnt lgkmcnt(8)
  v_mfma_f32_16x16x32_bf16 v[12:15], v[208:211], v[168:171], v[12:15]
  v_mfma_f32_16x16x32_bf16 v[44:47], v[208:211], v[176:179], v[44:47]
  s_waitcnt lgkmcnt(6)
  v_mfma_f32_16x16x32_bf16 v[16:19], v[212:215], v[168:171], v[16:19]
  v_mfma_f32_16x16x32_bf16 v[48:51], v[212:215], v[176:179], v[48:51]
  s_waitcnt lgkmcnt(4)
  v_mfma_f32_16x16x32_bf16 v[20:23], v[216:219], v[168:171], v[20:23]
  v_mfma_f32_16x16x32_bf16 v[52:55], v[216:219], v[176:179], v[52:55]
  s_waitcnt lgkmcnt(2)
  v_mfma_f32_16x16x32_bf16 v[24:27], v[220:223], v[168:171], v[24:27]
  v_mfma_f32_16x16x32_bf16 v[56:59], v[220:223], v[176:179], v[56:59]
  s_waitcnt lgkmcnt(0)
  v_mfma_f32_16x16x32_bf16 v[28:31], v[224:227], v[168:171], v[28:31]
  v_mfma_f32_16x16x32_bf16 v[60:63], v[224:227], v[176:179], v[60:63]
  s_branch ST_2_done
ST_2e:
  ds_read_b128 v[196:199], v228 offset:16384
  ds_read_b128 v[200:203], v228 offset:20480
  ds_read_b128 v[204:207], v229 offset:16384
  ds_read_b128 v[208:211], v229 offset:20480
  ds_read_b128 v[212:215], v230 offset:16384
  ds_read_b128 v[216:219], v230 offset:20480
  ds_read_b128 v[220:223], v231 offset:16384
  ds_read_b128 v[224:227], v231 offset:20480
  s_waitcnt lgkmcnt(7)
  v_mfma_f32_16x16x32_bf16 v[168:171], v[196:199], v[108:111], v[156:159]
  v_mfma_f32_16x16x32_bf16 v[176:179], v[196:199], v[124:127], v[160:163]
  v_mfma_f32_16x16x32_bf16 v[184:187], v[196:199], v[140:143], v[164:167]
  ds_read_b64_tr_b16 v[196:197], v232 offset:24576
  ds_read_b64_tr_b16 v[198:199], v232 offset:28672
  s_waitcnt lgkmcnt(8)
  v_mfma_f32_16x16x32_bf16 v[172:175], v[200:203], v[108:111], v[156:159]
  v_mfma_f32_16x16x32_bf16 v[180:183], v[200:203], v[124:127], v[160:163]
  v_mfma_f32_16x16x32_bf16 v[188:191], v[200:203], v[140:143], v[164:167]
  ds_read_b64_tr_b16 v[200:201], v233 offset:24576
  ds_read_b64_tr_b16 v[202:203], v233 offset:28672
  s_waitcnt lgkmcnt(9)
  v_mfma_f32_16x16x32_bf16 v[168:171], v[204:207], v[112:115], v[168:171]
  v_mfma_f32_16x16x32_bf16 v[176:179], v[204:207], v[128:131], v[176:179]
  v_mfma_f32_16x16x32_bf16 v[184:187], v[204:207], v[144:147], v[184:187]
  ds_read_b64_tr_b16 v[204:205], v234 offset:24576
  ds_read_b64_tr_b16 v[206:207], v234 offset:28672
  s_waitcnt lgkmcnt(10)
  v_mfma_f32_16x16x32_bf16 v[172:175], v[208:211], v[112:115], v[172:175]
  v_mfma_f32_16x16x32_bf16 v[180:183], v[208:211], v[128:131], v[180:183]
  v_mfma_f32_16x16x32_bf16 v[188:191], v[208:211], v[144:147], v[188:191]
  ds_read_b64_tr_b16 v[208:209], v235 offset:24576
  ds_read_b64_tr_b16 v[210:211], v235 offset:28672
  s_waitcnt lgkmcnt(11)
  v_mfma_f32_16x16x32_bf16 v[168:171], v[212:215], v[116:119], v[168:171]
  v_mfma_f32_16x16x32_bf16 v[176:179], v[212:215], v[132:135], v[176:179]
  v_mfma_f32_16x16x32_bf16 v[184:187], v[212:215], v[148:151], v[184:187]
  ds_read_b64_tr_b16 v[212:213], v236 offset:24576
  ds_read_b64_tr_b16 v[214:215], v236 offset:28672
  s_waitcnt lgkmcnt(12)
  v_mfma_f32_16x16x32_bf16 v[172:175], v[216:219], v[116:119], v[172:175]
  v_mfma_f32_16x16x32_bf16 v[180:183], v[216:219], v[132:135], v[180:183]
  v_mfma_f32_16x16x32_bf16 v[188:191], v[216:219], v[148:151], v[188:191]
  ds_read_b64_tr_b16 v[216:217], v237 offset:24576
  ds_read_b64_tr_b16 v[218:219], v237 offset:28672
  s_waitcnt lgkmcnt(13)
  v_mfma_f32_16x16x32_bf16 v[168:171], v[220:223], v[120:123], v[168:171]
  v_mfma_f32_16x16x32_bf16 v[176:179], v[220:223], v[136:139], v[176:179]
  v_mfma_f32_16x16x32_bf16 v[184:187], v[220:223], v[152:155], v[184:187]
  ds_read_b64_tr_b16 v[220:221], v238 offset:24576
  ds_read_b64_tr_b16 v[222:223], v238 offset:28672
  s_waitcnt lgkmcnt(14)
  v_mfma_f32_16x16x32_bf16 v[172:175], v[224:227], v[120:123], v[172:175]
  v_mfma_f32_16x16x32_bf16 v[180:183], v[224:227], v[136:139], v[180:183]
  v_mfma_f32_16x16x32_bf16 v[188:191], v[224:227], v[152:155], v[188:191]
  ds_read_b64_tr_b16 v[224:225], v239 offset:24576
  ds_read_b64_tr_b16 v[226:227], v239 offset:28672
  s_nop 5
  v_max3_f32 v244, v168, v169, v170
  v_max3_f32 v245, v171, v172, v173
  v_max3_f32 v244, v244, v174, v175
  v_max3_f32 v245, v245, v176, v177
  v_max3_f32 v244, v244, v178, v179
  v_max3_f32 v245, v245, v180, v181
  v_max3_f32 v244, v244, v182, v183
  v_max_f32 v244, v244, v245
  v_cmp_lt_f32 vcc, s28, v244
  s_cbranch_vccnz SLOWM_2e
RETM_2e:
  v_max3_f32 v244, v184, v185, v186
  v_max3_f32 v245, v187, v188, v189
  v_max3_f32 v244, v244, v190, v191
  v_max_f32 v244, v244, v245
  v_cmp_lt_f32 vcc, s30, v244
  s_cbranch_vccnz SLOWE_2e
RETE_2e:
  v_exp_f32 v168, v168
  v_exp_f32 v169, v169
  v_exp_f32 v170, v170
  v_exp_f32 v171, v171
  v_exp_f32 v172, v172
  v_exp_f32 v173, v173
  v_exp_f32 v174, v174
  v_exp_f32 v175, v175
  v_exp_f32 v176, v176
  v_exp_f32 v177, v177
  v_exp_f32 v178, v178
  v_exp_f32 v179, v179
  v_exp_f32 v180, v180
  v_exp_f32 v181, v181
  v_exp_f32 v182, v182
  v_exp_f32 v183, v183
  v_exp_f32 v184, v184
  v_exp_f32 v185, v185
  v_exp_f32 v186, v186
  v_exp_f32 v187, v187
  v_exp_f32 v188, v188
  v_exp_f32 v189, v189
  v_exp_f32 v190, v190
  v_exp_f32 v191, v191
  v_cvt_pk_bf16_f32 v168, v168, v169
  v_cvt_pk_bf16_f32 v169, v170, v171
  v_cvt_pk_bf16_f32 v170, v172, v173
  v_cvt_pk_bf16_f32 v171, v174, v175
  v_cvt_pk_bf16_f32 v176, v176, v177
  v_cvt_pk_bf16_f32 v177, v178, v179
  v_cvt_pk_bf16_f32 v178, v180, v181
  v_cvt_pk_bf16_f32 v179, v182, v183
  v_cvt_pk_bf16_f32 v184, v184, v185
  v_cvt_pk_bf16_f32 v185, v186, v187
  v_cvt_pk_bf16_f32 v186, v188, v189
  v_cvt_pk_bf16_f32 v187, v190, v191
  s_nop 1
  v_mfma_f32_16x16x32_bf16 v[96:99], v[192:195], v[168:171], v[96:99]
  v_mfma_f32_16x16x32_bf16 v[100:103], v[192:195], v[176:179], v[100:103]
  v_mfma_f32_16x16x32_bf16 v[104:107], v[192:195], v[184:187], v[104:107]
  s_waitcnt lgkmcnt(14)
  v_mfma_f32_16x16x32_bf16 v[0:3], v[196:199], v[168:171], v[0:3]
  v_mfma_f32_16x16x32_bf16 v[32:35], v[196:199], v[176:179], v[32:35]
  v_mfma_f32_16x16x32_bf16 v[64:67], v[196:199], v[184:187], v[64:67]
  s_waitcnt lgkmcnt(12)
  v_mfma_f32_16x16x32_bf16 v[4:7], v[200:203], v[168:171], v[4:7]
  v_mfma_f32_16x16x32_bf16 v[36:39], v[200:203], v[176:179], v[36:39]
  v_mfma_f32_16x16x32_bf16 v[68:71], v[200:203], v[184:187], v[68:71]
  s_waitcnt lgkmcnt(10)
  v_mfma_f32_16x16x32_bf16 v[8:11], v[204:207], v[168:171], v[8:11]
  v_mfma_f32_16x16x32_bf16 v[40:43], v[204:207], v[176:179], v[40:43]
  v_mfma_f32_16x16x32_bf16 v[72:75], v[204:207], v[184:187], v[72:75]
  s_waitcnt lgkmcnt(8)
  v_mfma_f32_16x16x32_bf16 v[12:15], v[208:211], v[168:171], v[12:15]
  v_mfma_f32_16x16x32_bf16 v[44:47], v[208:211], v[176:179], v[44:47]
  v_mfma_f32_16x16x32_bf16 v[76:79], v[208:211], v[184:187], v[76:79]
  s_waitcnt lgkmcnt(6)
  v_mfma_f32_16x16x32_bf16 v[16:19], v[212:215], v[168:171], v[16:19]
  v_mfma_f32_16x16x32_bf16 v[48:51], v[212:215], v[176:179], v[48:51]
  v_mfma_f32_16x16x32_bf16 v[80:83], v[212:215], v[184:187], v[80:83]
  s_waitcnt lgkmcnt(4)
  v_mfma_f32_16x16x32_bf16 v[20:23], v[216:219], v[168:171], v[20:23]
  v_mfma_f32_16x16x32_bf16 v[52:55], v[216:219], v[176:179], v[52:55]
  v_mfma_f32_16x16x32_bf16 v[84:87], v[216:219], v[184:187], v[84:87]
  s_waitcnt lgkmcnt(2)
  v_mfma_f32_16x16x32_bf16 v[24:27], v[220:223], v[168:171], v[24:27]
  v_mfma_f32_16x16x32_bf16 v[56:59], v[220:223], v[176:179], v[56:59]
  v_mfma_f32_16x16x32_bf16 v[88:91], v[220:223], v[184:187], v[88:91]
  s_waitcnt lgkmcnt(0)
  v_mfma_f32_16x16x32_bf16 v[28:31], v[224:227], v[168:171], v[28:31]
  v_mfma_f32_16x16x32_bf16 v[60:63], v[224:227], v[176:179], v[60:63]
  v_mfma_f32_16x16x32_bf16 v[92:95], v[224:227], v[184:187], v[92:95]
ST_2_done:
  s_waitcnt vmcnt(8)
  s_barrier
  s_add_u32 m0, s27, 0x4000
  s_nop 0
  buffer_load_dwordx4 v240, s[4:7], s25 offen nt lds
  s_add_u32 m0, s27, 0x4400
  s_nop 0
  buffer_load_dwordx4 v241, s[4:7], s25 offen nt lds
  s_add_u32 m0, s27, 0x6000
  s_nop 0
  buffer_load_dwordx4 v242, s[8:11], s25 offen nt lds
  s_add_u32 m0, s27, 0x6400
  s_nop 0
  buffer_load_dwordx4 v243, s[8:11], s25 offen nt lds
  s_add_u32 s25, s25, 8192
  s_cmp_eq_u32 s24, 3
  s_cbranch_scc1 ST_3e
  ds_read_b128 v[196:199], v228 offset:49152
  ds_read_b128 v[200:203], v228 offset:53248
  ds_read_b128 v[204:207], v229 offset:49152
  ds_read_b128 v[208:211], v229 offset:53248
  ds_read_b128 v[212:215], v230 offset:49152
  ds_read_b128 v[216:219], v230 offset:53248
  ds_read_b128 v[220:223], v231 offset:49152
  ds_read_b128 v[224:227], v231 offset:53248
  s_waitcnt lgkmcnt(7)
  v_mfma_f32_16x16x32_bf16 v[168:171], v[196:199], v[108:111], v[156:159]
  v_mfma_f32_16x16x32_bf16 v[176:179], v[196:199], v[124:127], v[160:163]
  ds_read_b64_tr_b16 v[196:197], v232 offset:57344
  ds_read_b64_tr_b16 v[198:199], v232 offset:61440
  s_waitcnt lgkmcnt(8)
  v_mfma_f32_16x16x32_bf16 v[172:175], v[200:203], v[108:111], v[156:159]
  v_mfma_f32_16x16x32_bf16 v[180:183], v[200:203], v[124:127], v[160:163]
  ds_read_b64_tr_b16 v[200:201], v233 offset:57344
  ds_read_b64_tr_b16 v[202:203], v233 offset:61440
  s_waitcnt lgkmcnt(9)
  v_mfma_f32_16x16x32_bf16 v[168:171], v[204:207], v[112:115], v[168:171]
  v_mfma_f32_16x16x32_bf16 v[176:179], v[204:207], v[128:131], v[176:179]
  ds_read_b64_tr_b16 v[204:205], v234 offset:57344
  ds_read_b64_tr_b16 v[206:207], v234 offset:61440
  s_waitcnt lgkmcnt(10)
  v_mfma_f32_16x16x32_bf16 v[172:175], v[208:211], v[112:115], v[172:175]
  v_mfma_f32_16x16x32_bf16 v[180:183], v[208:211], v[128:131], v[180:183]
  ds_read_b64_tr_b16 v[208:209], v235 offset:57344
  ds_read_b64_tr_b16 v[210:211], v235 offset:61440
  s_waitcnt lgkmcnt(11)
  v_mfma_f32_16x16x32_bf16 v[168:171], v[212:215], v[116:119], v[168:171]
  v_mfma_f32_16x16x32_bf16 v[176:179], v[212:215], v[132:135], v[176:179]
  ds_read_b64_tr_b16 v[212:213], v236 offset:57344
  ds_read_b64_tr_b16 v[214:215], v236 offset:61440
  s_waitcnt lgkmcnt(12)
  v_mfma_f32_16x16x32_bf16 v[172:175], v[216:219], v[116:119], v[172:175]
  v_mfma_f32_16x16x32_bf16 v[180:183], v[216:219], v[132:135], v[180:183]
  ds_read_b64_tr_b16 v[216:217], v237 offset:57344
  ds_read_b64_tr_b16 v[218:219], v237 offset:61440
  s_waitcnt lgkmcnt(13)
  v_mfma_f32_16x16x32_bf16 v[168:171], v[220:223], v[120:123], v[168:171]
  v_mfma_f32_16x16x32_bf16 v[176:179], v[220:223], v[136:139], v[176:179]
  ds_read_b64_tr_b16 v[220:221], v238 offset:57344
  ds_read_b64_tr_b16 v[222:223], v238 offset:61440
  s_waitcnt lgkmcnt(14)
  v_mfma_f32_16x16x32_bf16 v[172:175], v[224:227], v[120:123], v[172:175]
  v_mfma_f32_16x16x32_bf16 v[180:183], v[224:227], v[136:139], v[180:183]
  ds_read_b64_tr_b16 v[224:225], v239 offset:57344
  ds_read_b64_tr_b16 v[226:227], v239 offset:61440
  s_nop 5
  v_max3_f32 v244, v168, v169, v170
  v_max3_f32 v245, v171, v172, v173
  v_max3_f32 v244, v244, v174, v175
  v_max3_f32 v245, v245, v176, v177
  v_max3_f32 v244, v244, v178, v179
  v_max3_f32 v245, v245, v180, v181
  v_max3_f32 v244, v244, v182, v183
  v_max_f32 v244, v244, v245
  v_cmp_lt_f32 vcc, s28, v244
  s_cbranch_vccnz SLOWM_3n
RETM_3n:
  v_exp_f32 v168, v168
  v_exp_f32 v169, v169
  v_exp_f32 v170, v170
  v_exp_f32 v171, v171
  v_exp_f32 v172, v172
  v_exp_f32 v173, v173
  v_exp_f32 v174, v174
  v_exp_f32 v175, v175
  v_exp_f32 v176, v176
  v_exp_f32 v177, v177
  v_exp_f32 v178, v178
  v_exp_f32 v179, v179
  v_exp_f32 v180, v180
  v_exp_f32 v181, v181
  v_exp_f32 v182, v182
  v_exp_f32 v183, v183
  v_cvt_pk_bf16_f32 v168, v168, v169
  v_cvt_pk_bf16_f32 v169, v170, v171
  v_cvt_pk_bf16_f32 v170, v172, v173
  v_cvt_pk_bf16_f32 v171, v174, v175
  v_cvt_pk_bf16_f32 v176, v176, v177
  v_cvt_pk_bf16_f32 v177, v178, v179
  v_cvt_pk_bf16_f32 v178, v180, v181
  v_cvt_pk_bf16_f32 v179, v182, v183
  s_nop 1
  v_mfma_f32_16x16x32_bf16 v[96:99], v[192:195], v[168:171], v[96:99]
  v_mfma_f32_16x16x32_bf16 v[100:103], v[192:195], v[176:179], v[100:103]
  s_waitcnt lgkmcnt(14)
  v_mfma_f32_16x16x32_bf16 v[0:3], v[196:199], v[168:171], v[0:3]
  v_mfma_f32_16x16x32_bf16 v[32:35], v[196:199], v[176:179], v[32:35]
  s_waitcnt lgkmcnt(12)
  v_mfma_f32_16x16x32_bf16 v[4:7], v[200:203], v[168:171], v[4:7]
  v_mfma_f32_16x16x32_bf16 v[36:39], v[200:203], v[176:179], v[36:39]
  s_waitcnt lgkmcnt(10)
  v_mfma_f32_16x16x32_bf16 v[8:11], v[204:207], v[168:171], v[8:11]
  v_mfma_f32_16x16x32_bf16 v[40:43], v[204:207], v[176:179], v[40:43]
  s_waitcnt lgkmcnt(8)
  v_mfma_f32_16x16x32_bf16 v[12:15], v[208:211], v[168:171], v[12:15]
  v_mfma_f32_16x16x32_bf16 v[44:47], v[208:211], v[176:179], v[44:47]
  s_waitcnt lgkmcnt(6)
  v_mfma_f32_16x16x32_bf16 v[16:19], v[212:215], v[168:171], v[16:19]
  v_mfma_f32_16x16x32_bf16 v[48:51], v[212:215], v[176:179], v[48:51]
  s_waitcnt lgkmcnt(4)
  v_mfma_f32_16x16x32_bf16 v[20:23], v[216:219], v[168:171], v[20:23]
  v_mfma_f32_16x16x32_bf16 v[52:55], v[216:219], v[176:179], v[52:55]
  s_waitcnt lgkmcnt(2)
  v_mfma_f32_16x16x32_bf16 v[24:27], v[220:223], v[168:171], v[24:27]
  v_mfma_f32_16x16x32_bf16 v[56:59], v[220:223], v[176:179], v[56:59]
  s_waitcnt lgkmcnt(0)
  v_mfma_f32_16x16x32_bf16 v[28:31], v[224:227], v[168:171], v[28:31]
  v_mfma_f32_16x16x32_bf16 v[60:63], v[224:227], v[176:179], v[60:63]
  s_branch ST_3_done
ST_3e:
  ds_read_b128 v[196:199], v228 offset:49152
  ds_read_b128 v[200:203], v228 offset:53248
  ds_read_b128 v[204:207], v229 offset:49152
  ds_read_b128 v[208:211], v229 offset:53248
  ds_read_b128 v[212:215], v230 offset:49152
  ds_read_b128 v[216:219], v230 offset:53248
  ds_read_b128 v[220:223], v231 offset:49152
  ds_read_b128 v[224:227], v231 offset:53248
  s_waitcnt lgkmcnt(7)
  v_mfma_f32_16x16x32_bf16 v[168:171], v[196:199], v[108:111], v[156:159]
  v_mfma_f32_16x16x32_bf16 v[176:179], v[196:199], v[124:127], v[160:163]
  v_mfma_f32_16x16x32_bf16 v[184:187], v[196:199], v[140:143], v[164:167]
  ds_read_b64_tr_b16 v[196:197], v232 offset:57344
  ds_read_b64_tr_b16 v[198:199], v232 offset:61440
  s_waitcnt lgkmcnt(8)
  v_mfma_f32_16x16x32_bf16 v[172:175], v[200:203], v[108:111], v[156:159]
  v_mfma_f32_16x16x32_bf16 v[180:183], v[200:203], v[124:127], v[160:163]
  v_mfma_f32_16x16x32_bf16 v[188:191], v[200:203], v[140:143], v[164:167]
  ds_read_b64_tr_b16 v[200:201], v233 offset:57344
  ds_read_b64_tr_b16 v[202:203], v233 offset:61440
  s_waitcnt lgkmcnt(9)
  v_mfma_f32_16x16x32_bf16 v[168:171], v[204:207], v[112:115], v[168:171]
  v_mfma_f32_16x16x32_bf16 v[176:179], v[204:207], v[128:131], v[176:179]
  v_mfma_f32_16x16x32_bf16 v[184:187], v[204:207], v[144:147], v[184:187]
  ds_read_b64_tr_b16 v[204:205], v234 offset:57344
  ds_read_b64_tr_b16 v[206:207], v234 offset:61440
  s_waitcnt lgkmcnt(10)
  v_mfma_f32_16x16x32_bf16 v[172:175], v[208:211], v[112:115], v[172:175]
  v_mfma_f32_16x16x32_bf16 v[180:183], v[208:211], v[128:131], v[180:183]
  v_mfma_f32_16x16x32_bf16 v[188:191], v[208:211], v[144:147], v[188:191]
  ds_read_b64_tr_b16 v[208:209], v235 offset:57344
  ds_read_b64_tr_b16 v[210:211], v235 offset:61440
  s_waitcnt lgkmcnt(11)
  v_mfma_f32_16x16x32_bf16 v[168:171], v[212:215], v[116:119], v[168:171]
  v_mfma_f32_16x16x32_bf16 v[176:179], v[212:215], v[132:135], v[176:179]
  v_mfma_f32_16x16x32_bf16 v[184:187], v[212:215], v[148:151], v[184:187]
  ds_read_b64_tr_b16 v[212:213], v236 offset:57344
  ds_read_b64_tr_b16 v[214:215], v236 offset:61440
  s_waitcnt lgkmcnt(12)
  v_mfma_f32_16x16x32_bf16 v[172:175], v[216:219], v[116:119], v[172:175]
  v_mfma_f32_16x16x32_bf16 v[180:183], v[216:219], v[132:135], v[180:183]
  v_mfma_f32_16x16x32_bf16 v[188:191], v[216:219], v[148:151], v[188:191]
  ds_read_b64_tr_b16 v[216:217], v237 offset:57344
  ds_read_b64_tr_b16 v[218:219], v237 offset:61440
  s_waitcnt lgkmcnt(13)
  v_mfma_f32_16x16x32_bf16 v[168:171], v[220:223], v[120:123], v[168:171]
  v_mfma_f32_16x16x32_bf16 v[176:179], v[220:223], v[136:139], v[176:179]
  v_mfma_f32_16x16x32_bf16 v[184:187], v[220:223], v[152:155], v[184:187]
  ds_read_b64_tr_b16 v[220:221], v238 offset:57344
  ds_read_b64_tr_b16 v[222:223], v238 offset:61440
  s_waitcnt lgkmcnt(14)
  v_mfma_f32_16x16x32_bf16 v[172:175], v[224:227], v[120:123], v[172:175]
  v_mfma_f32_16x16x32_bf16 v[180:183], v[224:227], v[136:139], v[180:183]
  v_mfma_f32_16x16x32_bf16 v[188:191], v[224:227], v[152:155], v[188:191]
  ds_read_b64_tr_b16 v[224:225], v239 offset:57344
  ds_read_b64_tr_b16 v[226:227], v239 offset:61440
  s_nop 5
  v_max3_f32 v244, v168, v169, v170
  v_max3_f32 v245, v171, v172, v173
  v_max3_f32 v244, v244, v174, v175
  v_max3_f32 v245, v245, v176, v177
  v_max3_f32 v244, v244, v178, v179
  v_max3_f32 v245, v245, v180, v181
  v_max3_f32 v244, v244, v182, v183
  v_max_f32 v244, v244, v245
  v_cmp_lt_f32 vcc, s28, v244
  s_cbranch_vccnz SLOWM_3e
RETM_3e:
  v_max3_f32 v244, v184, v185, v186
  v_max3_f32 v245, v187, v188, v189
  v_max3_f32 v244, v244, v190, v191
  v_max_f32 v244, v244, v245
  v_cmp_lt_f32 vcc, s30, v244
  s_cbranch_vccnz SLOWE_3e
RETE_3e:
  v_exp_f32 v168, v168
  v_exp_f32 v169, v169
  v_exp_f32 v170, v170
  v_exp_f32 v171, v171
  v_exp_f32 v172, v172
  v_exp_f32 v173, v173
  v_exp_f32 v174, v174
  v_exp_f32 v175, v175
  v_exp_f32 v176, v176
  v_exp_f32 v177, v177
  v_exp_f32 v178, v178
  v_exp_f32 v179, v179
  v_exp_f32 v180, v180
  v_exp_f32 v181, v181
  v_exp_f32 v182, v182
  v_exp_f32 v183, v183
  v_exp_f32 v184, v184
  v_exp_f32 v185, v185
  v_exp_f32 v186, v186
  v_exp_f32 v187, v187
  v_exp_f32 v188, v188
  v_exp_f32 v189, v189
  v_exp_f32 v190, v190
  v_exp_f32 v191, v191
  v_cvt_pk_bf16_f32 v168, v168, v169
  v_cvt_pk_bf16_f32 v169, v170, v171
  v_cvt_pk_bf16_f32 v170, v172, v173
  v_cvt_pk_bf16_f32 v171, v174, v175
  v_cvt_pk_bf16_f32 v176, v176, v177
  v_cvt_pk_bf16_f32 v177, v178, v179
  v_cvt_pk_bf16_f32 v178, v180, v181
  v_cvt_pk_bf16_f32 v179, v182, v183
  v_cvt_pk_bf16_f32 v184, v184, v185
  v_cvt_pk_bf16_f32 v185, v186, v187
  v_cvt_pk_bf16_f32 v186, v188, v189
  v_cvt_pk_bf16_f32 v187, v190, v191
  s_nop 1
  v_mfma_f32_16x16x32_bf16 v[96:99], v[192:195], v[168:171], v[96:99]
  v_mfma_f32_16x16x32_bf16 v[100:103], v[192:195], v[176:179], v[100:103]
  v_mfma_f32_16x16x32_bf16 v[104:107], v[192:195], v[184:187], v[104:107]
  s_waitcnt lgkmcnt(14)
  v_mfma_f32_16x16x32_bf16 v[0:3], v[196:199], v[168:171], v[0:3]
  v_mfma_f32_16x16x32_bf16 v[32:35], v[196:199], v[176:179], v[32:35]
  v_mfma_f32_16x16x32_bf16 v[64:67], v[196:199], v[184:187], v[64:67]
  s_waitcnt lgkmcnt(12)
  v_mfma_f32_16x16x32_bf16 v[4:7], v[200:203], v[168:171], v[4:7]
  v_mfma_f32_16x16x32_bf16 v[36:39], v[200:203], v[176:179], v[36:39]
  v_mfma_f32_16x16x32_bf16 v[68:71], v[200:203], v[184:187], v[68:71]
  s_waitcnt lgkmcnt(10)
  v_mfma_f32_16x16x32_bf16 v[8:11], v[204:207], v[168:171], v[8:11]
  v_mfma_f32_16x16x32_bf16 v[40:43], v[204:207], v[176:179], v[40:43]
  v_mfma_f32_16x16x32_bf16 v[72:75], v[204:207], v[184:187], v[72:75]
  s_waitcnt lgkmcnt(8)
  v_mfma_f32_16x16x32_bf16 v[12:15], v[208:211], v[168:171], v[12:15]
  v_mfma_f32_16x16x32_bf16 v[44:47], v[208:211], v[176:179], v[44:47]
  v_mfma_f32_16x16x32_bf16 v[76:79], v[208:211], v[184:187], v[76:79]
  s_waitcnt lgkmcnt(6)
  v_mfma_f32_16x16x32_bf16 v[16:19], v[212:215], v[168:171], v[16:19]
  v_mfma_f32_16x16x32_bf16 v[48:51], v[212:215], v[176:179], v[48:51]
  v_mfma_f32_16x16x32_bf16 v[80:83], v[212:215], v[184:187], v[80:83]
  s_waitcnt lgkmcnt(4)
  v_mfma_f32_16x16x32_bf16 v[20:23], v[216:219], v[168:171], v[20:23]
  v_mfma_f32_16x16x32_bf16 v[52:55], v[216:219], v[176:179], v[52:55]
  v_mfma_f32_16x16x32_bf16 v[84:87], v[216:219], v[184:187], v[84:87]
  s_waitcnt lgkmcnt(2)
  v_mfma_f32_16x16x32_bf16 v[24:27], v[220:223], v[168:171], v[24:27]
  v_mfma_f32_16x16x32_bf16 v[56:59], v[220:223], v[176:179], v[56:59]
  v_mfma_f32_16x16x32_bf16 v[88:91], v[220:223], v[184:187], v[88:91]
  s_waitcnt lgkmcnt(0)
  v_mfma_f32_16x16x32_bf16 v[28:31], v[224:227], v[168:171], v[28:31]
  v_mfma_f32_16x16x32_bf16 v[60:63], v[224:227], v[176:179], v[60:63]
  v_mfma_f32_16x16x32_bf16 v[92:95], v[224:227], v[184:187], v[92:95]
ST_3_done:
  s_sub_u32 s26, s26, 1
  s_cmp_lg_u32 s26, 0
  s_cbranch_scc1 K1_LOOP
  s_waitcnt vmcnt(0)
  v_lshlrev_b32 v253, 2, v252
  s_lshl_b32 s33, s24, 12
  buffer_load_dword v254, v253, s[68:71], s33 offen
  s_nop 7
  s_lshl_b32 s33, s24, 18
  s_add_u32 s34, s33, 131072
  v_rcp_f32 v244, v96
  s_nop 0
  v_mul_f32 v0, v244, v0
  v_mul_f32 v1, v244, v1
  v_mul_f32 v2, v244, v2
  v_mul_f32 v3, v244, v3
  v_mul_f32 v4, v244, v4
  v_mul_f32 v5, v244, v5
  v_mul_f32 v6, v244, v6
  v_mul_f32 v7, v244, v7
  v_mul_f32 v8, v244, v8
  v_mul_f32 v9, v244, v9
  v_mul_f32 v10, v244, v10
  v_mul_f32 v11, v244, v11
  v_mul_f32 v12, v244, v12
  v_mul_f32 v13, v244, v13
  v_mul_f32 v14, v244, v14
  v_mul_f32 v15, v244, v15
  v_mul_f32 v16, v244, v16
  v_mul_f32 v17, v244, v17
  v_mul_f32 v18, v244, v18
  v_mul_f32 v19, v244, v19
  v_mul_f32 v20, v244, v20
  v_mul_f32 v21, v244, v21
  v_mul_f32 v22, v244, v22
  v_mul_f32 v23, v244, v23
  v_mul_f32 v24, v244, v24
  v_mul_f32 v25, v244, v25
  v_mul_f32 v26, v244, v26
  v_mul_f32 v27, v244, v27
  v_mul_f32 v28, v244, v28
  v_mul_f32 v29, v244, v29
  v_mul_f32 v30, v244, v30
  v_mul_f32 v31, v244, v31
  v_cvt_pk_bf16_f32 v196, v0, v1
  v_cvt_pk_bf16_f32 v197, v2, v3
  v_cvt_pk_bf16_f32 v198, v4, v5
  v_cvt_pk_bf16_f32 v199, v6, v7
  buffer_store_dwordx4 v[196:199], v252, s[20:23], s33 offen offset:0 sc1
  v_cvt_pk_bf16_f32 v200, v8, v9
  v_cvt_pk_bf16_f32 v201, v10, v11
  v_cvt_pk_bf16_f32 v202, v12, v13
  v_cvt_pk_bf16_f32 v203, v14, v15
  buffer_store_dwordx4 v[200:203], v252, s[20:23], s33 offen offset:1024 sc1
  v_cvt_pk_bf16_f32 v204, v16, v17
  v_cvt_pk_bf16_f32 v205, v18, v19
  v_cvt_pk_bf16_f32 v206, v20, v21
  v_cvt_pk_bf16_f32 v207, v22, v23
  buffer_store_dwordx4 v[204:207], v252, s[20:23], s33 offen offset:2048 sc1
  v_cvt_pk_bf16_f32 v208, v24, v25
  v_cvt_pk_bf16_f32 v209, v26, v27
  v_cvt_pk_bf16_f32 v210, v28, v29
  v_cvt_pk_bf16_f32 v211, v30, v31
  buffer_store_dwordx4 v[208:211], v252, s[20:23], s33 offen offset:3072 sc1
  v_rcp_f32 v244, v100
  s_nop 0
  v_mul_f32 v32, v244, v32
  v_mul_f32 v33, v244, v33
  v_mul_f32 v34, v244, v34
  v_mul_f32 v35, v244, v35
  v_mul_f32 v36, v244, v36
  v_mul_f32 v37, v244, v37
  v_mul_f32 v38, v244, v38
  v_mul_f32 v39, v244, v39
  v_mul_f32 v40, v244, v40
  v_mul_f32 v41, v244, v41
  v_mul_f32 v42, v244, v42
  v_mul_f32 v43, v244, v43
  v_mul_f32 v44, v244, v44
  v_mul_f32 v45, v244, v45
  v_mul_f32 v46, v244, v46
  v_mul_f32 v47, v244, v47
  v_mul_f32 v48, v244, v48
  v_mul_f32 v49, v244, v49
  v_mul_f32 v50, v244, v50
  v_mul_f32 v51, v244, v51
  v_mul_f32 v52, v244, v52
  v_mul_f32 v53, v244, v53
  v_mul_f32 v54, v244, v54
  v_mul_f32 v55, v244, v55
  v_mul_f32 v56, v244, v56
  v_mul_f32 v57, v244, v57
  v_mul_f32 v58, v244, v58
  v_mul_f32 v59, v244, v59
  v_mul_f32 v60, v244, v60
  v_mul_f32 v61, v244, v61
  v_mul_f32 v62, v244, v62
  v_mul_f32 v63, v244, v63
  v_cvt_pk_bf16_f32 v212, v32, v33
  v_cvt_pk_bf16_f32 v213, v34, v35
  v_cvt_pk_bf16_f32 v214, v36, v37
  v_cvt_pk_bf16_f32 v215, v38, v39
  buffer_store_dwordx4 v[212:215], v252, s[20:23], s34 offen offset:0 sc1
  v_cvt_pk_bf16_f32 v216, v40, v41
  v_cvt_pk_bf16_f32 v217, v42, v43
  v_cvt_pk_bf16_f32 v218, v44, v45
  v_cvt_pk_bf16_f32 v219, v46, v47
  buffer_store_dwordx4 v[216:219], v252, s[20:23], s34 offen offset:1024 sc1
  v_cvt_pk_bf16_f32 v220, v48, v49
  v_cvt_pk_bf16_f32 v221, v50, v51
  v_cvt_pk_bf16_f32 v222, v52, v53
  v_cvt_pk_bf16_f32 v223, v54, v55
  buffer_store_dwordx4 v[220:223], v252, s[20:23], s34 offen offset:2048 sc1
  v_cvt_pk_bf16_f32 v224, v56, v57
  v_cvt_pk_bf16_f32 v225, v58, v59
  v_cvt_pk_bf16_f32 v226, v60, v61
  v_cvt_pk_bf16_f32 v227, v62, v63
  buffer_store_dwordx4 v[224:227], v252, s[20:23], s34 offen offset:3072 sc1
  s_lshl_b32 s35, s24, 8
  v_lshrrev_b32 v245, 2, v252
  v_add_u32 v246, s35, v245
  s_barrier
  ds_write_b32 v246, v164 offset:40960
  s_waitcnt lgkmcnt(0)
  s_barrier
  ds_read_b32 v248, v245 offset:40960
  ds_read_b32 v249, v245 offset:41216
  ds_read_b32 v250, v245 offset:41472
  ds_read_b32 v251, v245 offset:41728
  s_waitcnt lgkmcnt(0)
  v_min_f32 v248, v248, v249
  v_min3_f32 v248, v248, v250, v251
  v_sub_f32 v248, v248, v164
  v_exp_f32 v248, v248
  s_nop 0
  v_mul_f32 v64, v248, v64
  v_mul_f32 v65, v248, v65
  v_mul_f32 v66, v248, v66
  v_mul_f32 v67, v248, v67
  v_mul_f32 v68, v248, v68
  v_mul_f32 v69, v248, v69
  v_mul_f32 v70, v248, v70
  v_mul_f32 v71, v248, v71
  v_mul_f32 v72, v248, v72
  v_mul_f32 v73, v248, v73
  v_mul_f32 v74, v248, v74
  v_mul_f32 v75, v248, v75
  v_mul_f32 v76, v248, v76
  v_mul_f32 v77, v248, v77
  v_mul_f32 v78, v248, v78
  v_mul_f32 v79, v248, v79
  v_mul_f32 v80, v248, v80
  v_mul_f32 v81, v248, v81
  v_mul_f32 v82, v248, v82
  v_mul_f32 v83, v248, v83
  v_mul_f32 v84, v248, v84
  v_mul_f32 v85, v248, v85
  v_mul_f32 v86, v248, v86
  v_mul_f32 v87, v248, v87
  v_mul_f32 v88, v248, v88
  v_mul_f32 v89, v248, v89
  v_mul_f32 v90, v248, v90
  v_mul_f32 v91, v248, v91
  v_mul_f32 v92, v248, v92
  v_mul_f32 v93, v248, v93
  v_mul_f32 v94, v248, v94
  v_mul_f32 v95, v248, v95
  v_mul_f32 v104, v248, v104
  s_lshl_b32 s36, s24, 13
  v_add_u32 v247, s36, v252
  ds_write_b128 v247, v[64:67] offset:0
  ds_write_b128 v247, v[68:71] offset:1024
  ds_write_b128 v247, v[72:75] offset:2048
  ds_write_b128 v247, v[76:79] offset:3072
  ds_write_b128 v247, v[80:83] offset:4096
  ds_write_b128 v247, v[84:87] offset:5120
  ds_write_b128 v247, v[88:91] offset:6144
  ds_write_b128 v247, v[92:95] offset:7168
  ds_write_b32 v246, v104 offset:32768
  s_waitcnt lgkmcnt(0)
  s_barrier
  s_lshl_b32 s36, s24, 11
  v_add_u32 v247, s36, v252
  ds_read_b128 v[0:3], v247 offset:0
  ds_read_b128 v[4:7], v247 offset:1024
  ds_read_b32 v248, v245 offset:32768
  ds_read_b128 v[8:11], v247 offset:8192
  ds_read_b128 v[12:15], v247 offset:9216
  ds_read_b32 v249, v245 offset:33024
  ds_read_b128 v[16:19], v247 offset:16384
  ds_read_b128 v[20:23], v247 offset:17408
  ds_read_b32 v250, v245 offset:33280
  ds_read_b128 v[24:27], v247 offset:24576
  ds_read_b128 v[28:31], v247 offset:25600
  ds_read_b32 v251, v245 offset:33536
  s_waitcnt lgkmcnt(0)
  v_add_f32 v248, v248, v249
  v_add_f32 v250, v250, v251
  v_add_f32 v248, v248, v250
  v_rcp_f32 v248, v248
  v_add_f32 v0, v0, v8
  v_add_f32 v16, v16, v24
  v_add_f32 v0, v0, v16
  v_mul_f32 v0, v248, v0
  v_add_f32 v1, v1, v9
  v_add_f32 v17, v17, v25
  v_add_f32 v1, v1, v17
  v_mul_f32 v1, v248, v1
  v_add_f32 v2, v2, v10
  v_add_f32 v18, v18, v26
  v_add_f32 v2, v2, v18
  v_mul_f32 v2, v248, v2
  v_add_f32 v3, v3, v11
  v_add_f32 v19, v19, v27
  v_add_f32 v3, v3, v19
  v_mul_f32 v3, v248, v3
  v_add_f32 v4, v4, v12
  v_add_f32 v20, v20, v28
  v_add_f32 v4, v4, v20
  v_mul_f32 v4, v248, v4
  v_add_f32 v5, v5, v13
  v_add_f32 v21, v21, v29
  v_add_f32 v5, v5, v21
  v_mul_f32 v5, v248, v5
  v_add_f32 v6, v6, v14
  v_add_f32 v22, v22, v30
  v_add_f32 v6, v6, v22
  v_mul_f32 v6, v248, v6
  v_add_f32 v7, v7, v15
  v_add_f32 v23, v23, v31
  v_add_f32 v7, v7, v23
  v_mul_f32 v7, v248, v7
  v_cvt_pk_bf16_f32 v168, v0, v1
  v_cvt_pk_bf16_f32 v169, v2, v3
  v_cvt_pk_bf16_f32 v170, v4, v5
  v_cvt_pk_bf16_f32 v171, v6, v7
  s_lshl_b32 s36, s24, 10
  s_add_u32 s36, s36, 1048576
  buffer_store_dwordx4 v[168:171], v252, s[20:23], s36 offen sc1
  s_waitcnt vmcnt(0)
K1_END:
  s_endpgm
SLOWM_0n:
  v_lshrrev_b32 v248, 2, v252
  v_xor_b32 v249, 64, v248
  v_xor_b32 v250, 128, v248
  v_max3_f32 v244, v168, v169, v170
  v_max3_f32 v244, v244, v171, v172
  v_max3_f32 v244, v244, v173, v174
  v_max_f32 v244, v244, v175
  ds_bpermute_b32 v245, v249, v244
  s_waitcnt lgkmcnt(0)
  v_max_f32 v244, v244, v245
  ds_bpermute_b32 v245, v250, v244
  s_waitcnt lgkmcnt(0)
  v_max_f32 v244, v244, v245
  v_max_f32 v244, s29, v244
  v_sub_f32 v168, v168, v244
  v_sub_f32 v169, v169, v244
  v_sub_f32 v170, v170, v244
  v_sub_f32 v171, v171, v244
  v_sub_f32 v172, v172, v244
  v_sub_f32 v173, v173, v244
  v_sub_f32 v174, v174, v244
  v_sub_f32 v175, v175, v244
  v_sub_f32 v156, v156, v244
  v_sub_f32 v157, v157, v244
  v_sub_f32 v158, v158, v244
  v_sub_f32 v159, v159, v244
  v_max_f32 v245, 0, v244
  v_exp_f32 v245, -v245
  s_nop 0
  v_mul_f32 v0, v245, v0
  v_mul_f32 v1, v245, v1
  v_mul_f32 v2, v245, v2
  v_mul_f32 v3, v245, v3
  v_mul_f32 v4, v245, v4
  v_mul_f32 v5, v245, v5
  v_mul_f32 v6, v245, v6
  v_mul_f32 v7, v245, v7
  v_mul_f32 v8, v245, v8
  v_mul_f32 v9, v245, v9
  v_mul_f32 v10, v245, v10
  v_mul_f32 v11, v245, v11
  v_mul_f32 v12, v245, v12
  v_mul_f32 v13, v245, v13
  v_mul_f32 v14, v245, v14
  v_mul_f32 v15, v245, v15
  v_mul_f32 v16, v245, v16
  v_mul_f32 v17, v245, v17
  v_mul_f32 v18, v245, v18
  v_mul_f32 v19, v245, v19
  v_mul_f32 v20, v245, v20
  v_mul_f32 v21, v245, v21
  v_mul_f32 v22, v245, v22
  v_mul_f32 v23, v245, v23
  v_mul_f32 v24, v245, v24
  v_mul_f32 v25, v245, v25
  v_mul_f32 v26, v245, v26
  v_mul_f32 v27, v245, v27
  v_mul_f32 v28, v245, v28
  v_mul_f32 v29, v245, v29
  v_mul_f32 v30, v245, v30
  v_mul_f32 v31, v245, v31
  v_mul_f32 v96, v245, v96
  v_mul_f32 v97, v245, v97
  v_mul_f32 v98, v245, v98
  v_mul_f32 v99, v245, v99
  v_max3_f32 v244, v176, v177, v178
  v_max3_f32 v244, v244, v179, v180
  v_max3_f32 v244, v244, v181, v182
  v_max_f32 v244, v244, v183
  ds_bpermute_b32 v245, v249, v244
  s_waitcnt lgkmcnt(0)
  v_max_f32 v244, v244, v245
  ds_bpermute_b32 v245, v250, v244
  s_waitcnt lgkmcnt(0)
  v_max_f32 v244, v244, v245
  v_max_f32 v244, s29, v244
  v_sub_f32 v176, v176, v244
  v_sub_f32 v177, v177, v244
  v_sub_f32 v178, v178, v244
  v_sub_f32 v179, v179, v244
  v_sub_f32 v180, v180, v244
  v_sub_f32 v181, v181, v244
  v_sub_f32 v182, v182, v244
  v_sub_f32 v183, v183, v244
  v_sub_f32 v160, v160, v244
  v_sub_f32 v161, v161, v244
  v_sub_f32 v162, v162, v244
  v_sub_f32 v163, v163, v244
  v_max_f32 v245, 0, v244
  v_exp_f32 v245, -v245
  s_nop 0
  v_mul_f32 v32, v245, v32
  v_mul_f32 v33, v245, v33
  v_mul_f32 v34, v245, v34
  v_mul_f32 v35, v245, v35
  v_mul_f32 v36, v245, v36
  v_mul_f32 v37, v245, v37
  v_mul_f32 v38, v245, v38
  v_mul_f32 v39, v245, v39
  v_mul_f32 v40, v245, v40
  v_mul_f32 v41, v245, v41
  v_mul_f32 v42, v245, v42
  v_mul_f32 v43, v245, v43
  v_mul_f32 v44, v245, v44
  v_mul_f32 v45, v245, v45
  v_mul_f32 v46, v245, v46
  v_mul_f32 v47, v245, v47
  v_mul_f32 v48, v245, v48
  v_mul_f32 v49, v245, v49
  v_mul_f32 v50, v245, v50
  v_mul_f32 v51, v245, v51
  v_mul_f32 v52, v245, v52
  v_mul_f32 v53, v245, v53
  v_mul_f32 v54, v245, v54
  v_mul_f32 v55, v245, v55
  v_mul_f32 v56, v245, v56
  v_mul_f32 v57, v245, v57
  v_mul_f32 v58, v245, v58
  v_mul_f32 v59, v245, v59
  v_mul_f32 v60, v245, v60
  v_mul_f32 v61, v245, v61
  v_mul_f32 v62, v245, v62
  v_mul_f32 v63, v245, v63
  v_mul_f32 v100, v245, v100
  v_mul_f32 v101, v245, v101
  v_mul_f32 v102, v245, v102
  v_mul_f32 v103, v245, v103
  s_mov_b32 s28, 0x41000000
  s_mov_b32 s29, 0
  s_branch RETM_0n
SLOWM_0e:
  v_lshrrev_b32 v248, 2, v252
  v_xor_b32 v249, 64, v248
  v_xor_b32 v250, 128, v248
  v_max3_f32 v244, v168, v169, v170
  v_max3_f32 v244, v244, v171, v172
  v_max3_f32 v244, v244, v173, v174
  v_max_f32 v244, v244, v175
  ds_bpermute_b32 v245, v249, v244
  s_waitcnt lgkmcnt(0)
  v_max_f32 v244, v244, v245
  ds_bpermute_b32 v245, v250, v244
  s_waitcnt lgkmcnt(0)
  v_max_f32 v244, v244, v245
  v_max_f32 v244, s29, v244
  v_sub_f32 v168, v168, v244
  v_sub_f32 v169, v169, v244
  v_sub_f32 v170, v170, v244
  v_sub_f32 v171, v171, v244
  v_sub_f32 v172, v172, v244
  v_sub_f32 v173, v173, v244
  v_sub_f32 v174, v174, v244
  v_sub_f32 v175, v175, v244
  v_sub_f32 v156, v156, v244
  v_sub_f32 v157, v157, v244
  v_sub_f32 v158, v158, v244
  v_sub_f32 v159, v159, v244
  v_max_f32 v245, 0, v244
  v_exp_f32 v245, -v245
  s_nop 0
  v_mul_f32 v0, v245, v0
  v_mul_f32 v1, v245, v1
  v_mul_f32 v2, v245, v2
  v_mul_f32 v3, v245, v3
  v_mul_f32 v4, v245, v4
  v_mul_f32 v5, v245, v5
  v_mul_f32 v6, v245, v6
  v_mul_f32 v7, v245, v7
  v_mul_f32 v8, v245, v8
  v_mul_f32 v9, v245, v9
  v_mul_f32 v10, v245, v10
  v_mul_f32 v11, v245, v11
  v_mul_f32 v12, v245, v12
  v_mul_f32 v13, v245, v13
  v_mul_f32 v14, v245, v14
  v_mul_f32 v15, v245, v15
  v_mul_f32 v16, v245, v16
  v_mul_f32 v17, v245, v17
  v_mul_f32 v18, v245, v18
  v_mul_f32 v19, v245, v19
  v_mul_f32 v20, v245, v20
  v_mul_f32 v21, v245, v21
  v_mul_f32 v22, v245, v22
  v_mul_f32 v23, v245, v23
  v_mul_f32 v24, v245, v24
  v_mul_f32 v25, v245, v25
  v_mul_f32 v26, v245, v26
  v_mul_f32 v27, v245, v27
  v_mul_f32 v28, v245, v28
  v_mul_f32 v29, v245, v29
  v_mul_f32 v30, v245, v30
  v_mul_f32 v31, v245, v31
  v_mul_f32 v96, v245, v96
  v_mul_f32 v97, v245, v97
  v_mul_f32 v98, v245, v98
  v_mul_f32 v99, v245, v99
  v_max3_f32 v244, v176, v177, v178
  v_max3_f32 v244, v244, v179, v180
  v_max3_f32 v244, v244, v181, v182
  v_max_f32 v244, v244, v183
  ds_bpermute_b32 v245, v249, v244
  s_waitcnt lgkmcnt(0)
  v_max_f32 v244, v244, v245
  ds_bpermute_b32 v245, v250, v244
  s_waitcnt lgkmcnt(0)
  v_max_f32 v244, v244, v245
  v_max_f32 v244, s29, v244
  v_sub_f32 v176, v176, v244
  v_sub_f32 v177, v177, v244
  v_sub_f32 v178, v178, v244
  v_sub_f32 v179, v179, v244
  v_sub_f32 v180, v180, v244
  v_sub_f32 v181, v181, v244
  v_sub_f32 v182, v182, v244
  v_sub_f32 v183, v183, v244
  v_sub_f32 v160, v160, v244
  v_sub_f32 v161, v161, v244
  v_sub_f32 v162, v162, v244
  v_sub_f32 v163, v163, v244
  v_max_f32 v245, 0, v244
  v_exp_f32 v245, -v245
  s_nop 0
  v_mul_f32 v32, v245, v32
  v_mul_f32 v33, v245, v33
  v_mul_f32 v34, v245, v34
  v_mul_f32 v35, v245, v35
  v_mul_f32 v36, v245, v36
  v_mul_f32 v37, v245, v37
  v_mul_f32 v38, v245, v38
  v_mul_f32 v39, v245, v39
  v_mul_f32 v40, v245, v40
  v_mul_f32 v41, v245, v41
  v_mul_f32 v42, v245, v42
  v_mul_f32 v43, v245, v43
  v_mul_f32 v44, v245, v44
  v_mul_f32 v45, v245, v45
  v_mul_f32 v46, v245, v46
  v_mul_f32 v47, v245, v47
  v_mul_f32 v48, v245, v48
  v_mul_f32 v49, v245, v49
  v_mul_f32 v50, v245, v50
  v_mul_f32 v51, v245, v51
  v_mul_f32 v52, v245, v52
  v_mul_f32 v53, v245, v53
  v_mul_f32 v54, v245, v54
  v_mul_f32 v55, v245, v55
  v_mul_f32 v56, v245, v56
  v_mul_f32 v57, v245, v57
  v_mul_f32 v58, v245, v58
  v_mul_f32 v59, v245, v59
  v_mul_f32 v60, v245, v60
  v_mul_f32 v61, v245, v61
  v_mul_f32 v62, v245, v62
  v_mul_f32 v63, v245, v63
  v_mul_f32 v100, v245, v100
  v_mul_f32 v101, v245, v101
  v_mul_f32 v102, v245, v102
  v_mul_f32 v103, v245, v103
  s_mov_b32 s28, 0x41000000
  s_mov_b32 s29, 0
  s_branch RETM_0e
SLOWE_0e:
  v_lshrrev_b32 v248, 2, v252
  v_xor_b32 v249, 64, v248
  v_xor_b32 v250, 128, v248
  v_max3_f32 v244, v184, v185, v186
  v_max3_f32 v244, v244, v187, v188
  v_max3_f32 v244, v244, v189, v190
  v_max_f32 v244, v244, v191
  ds_bpermute_b32 v245, v249, v244
  s_waitcnt lgkmcnt(0)
  v_max_f32 v244, v244, v245
  ds_bpermute_b32 v245, v250, v244
  s_waitcnt lgkmcnt(0)
  v_max_f32 v244, v244, v245
  v_max_f32 v244, s31, v244
  v_sub_f32 v184, v184, v244
  v_sub_f32 v185, v185, v244
  v_sub_f32 v186, v186, v244
  v_sub_f32 v187, v187, v244
  v_sub_f32 v188, v188, v244
  v_sub_f32 v189, v189, v244
  v_sub_f32 v190, v190, v244
  v_sub_f32 v191, v191, v244
  v_sub_f32 v164, v164, v244
  v_sub_f32 v165, v165, v244
  v_sub_f32 v166, v166, v244
  v_sub_f32 v167, v167, v244
  v_max_f32 v245, 0, v244
  v_exp_f32 v245, -v245
  s_nop 0
  v_mul_f32 v64, v245, v64
  v_mul_f32 v65, v245, v65
  v_mul_f32 v66, v245, v66
  v_mul_f32 v67, v245, v67
  v_mul_f32 v68, v245, v68
  v_mul_f32 v69, v245, v69
  v_mul_f32 v70, v245, v70
  v_mul_f32 v71, v245, v71
  v_mul_f32 v72, v245, v72
  v_mul_f32 v73, v245, v73
  v_mul_f32 v74, v245, v74
  v_mul_f32 v75, v245, v75
  v_mul_f32 v76, v245, v76
  v_mul_f32 v77, v245, v77
  v_mul_f32 v78, v245, v78
  v_mul_f32 v79, v245, v79
  v_mul_f32 v80, v245, v80
  v_mul_f32 v81, v245, v81
  v_mul_f32 v82, v245, v82
  v_mul_f32 v83, v245, v83
  v_mul_f32 v84, v245, v84
  v_mul_f32 v85, v245, v85
  v_mul_f32 v86, v245, v86
  v_mul_f32 v87, v245, v87
  v_mul_f32 v88, v245, v88
  v_mul_f32 v89, v245, v89
  v_mul_f32 v90, v245, v90
  v_mul_f32 v91, v245, v91
  v_mul_f32 v92, v245, v92
  v_mul_f32 v93, v245, v93
  v_mul_f32 v94, v245, v94
  v_mul_f32 v95, v245, v95
  v_mul_f32 v104, v245, v104
  v_mul_f32 v105, v245, v105
  v_mul_f32 v106, v245, v106
  v_mul_f32 v107, v245, v107
  s_mov_b32 s30, 0x41000000
  s_mov_b32 s31, 0
  s_branch RETE_0e
SLOWM_1n:
  v_lshrrev_b32 v248, 2, v252
  v_xor_b32 v249, 64, v248
  v_xor_b32 v250, 128, v248
  v_max3_f32 v244, v168, v169, v170
  v_max3_f32 v244, v244, v171, v172
  v_max3_f32 v244, v244, v173, v174
  v_max_f32 v244, v244, v175
  ds_bpermute_b32 v245, v249, v244
  s_waitcnt lgkmcnt(0)
  v_max_f32 v244, v244, v245
  ds_bpermute_b32 v245, v250, v244
  s_waitcnt lgkmcnt(0)
  v_max_f32 v244, v244, v245
  v_max_f32 v244, s29, v244
  v_sub_f32 v168, v168, v244
  v_sub_f32 v169, v169, v244
  v_sub_f32 v170, v170, v244
  v_sub_f32 v171, v171, v244
  v_sub_f32 v172, v172, v244
  v_sub_f32 v173, v173, v244
  v_sub_f32 v174, v174, v244
  v_sub_f32 v175, v175, v244
  v_sub_f32 v156, v156, v244
  v_sub_f32 v157, v157, v244
  v_sub_f32 v158, v158, v244
  v_sub_f32 v159, v159, v244
  v_max_f32 v245, 0, v244
  v_exp_f32 v245, -v245
  s_nop 0
  v_mul_f32 v0, v245, v0
  v_mul_f32 v1, v245, v1
  v_mul_f32 v2, v245, v2
  v_mul_f32 v3, v245, v3
  v_mul_f32 v4, v245, v4
  v_mul_f32 v5, v245, v5
  v_mul_f32 v6, v245, v6
  v_mul_f32 v7, v245, v7
  v_mul_f32 v8, v245, v8
  v_mul_f32 v9, v245, v9
  v_mul_f32 v10, v245, v10
  v_mul_f32 v11, v245, v11
  v_mul_f32 v12, v245, v12
  v_mul_f32 v13, v245, v13
  v_mul_f32 v14, v245, v14
  v_mul_f32 v15, v245, v15
  v_mul_f32 v16, v245, v16
  v_mul_f32 v17, v245, v17
  v_mul_f32 v18, v245, v18
  v_mul_f32 v19, v245, v19
  v_mul_f32 v20, v245, v20
  v_mul_f32 v21, v245, v21
  v_mul_f32 v22, v245, v22
  v_mul_f32 v23, v245, v23
  v_mul_f32 v24, v245, v24
  v_mul_f32 v25, v245, v25
  v_mul_f32 v26, v245, v26
  v_mul_f32 v27, v245, v27
  v_mul_f32 v28, v245, v28
  v_mul_f32 v29, v245, v29
  v_mul_f32 v30, v245, v30
  v_mul_f32 v31, v245, v31
  v_mul_f32 v96, v245, v96
  v_mul_f32 v97, v245, v97
  v_mul_f32 v98, v245, v98
  v_mul_f32 v99, v245, v99
  v_max3_f32 v244, v176, v177, v178
  v_max3_f32 v244, v244, v179, v180
  v_max3_f32 v244, v244, v181, v182
  v_max_f32 v244, v244, v183
  ds_bpermute_b32 v245, v249, v244
  s_waitcnt lgkmcnt(0)
  v_max_f32 v244, v244, v245
  ds_bpermute_b32 v245, v250, v244
  s_waitcnt lgkmcnt(0)
  v_max_f32 v244, v244, v245
  v_max_f32 v244, s29, v244
  v_sub_f32 v176, v176, v244
  v_sub_f32 v177, v177, v244
  v_sub_f32 v178, v178, v244
  v_sub_f32 v179, v179, v244
  v_sub_f32 v180, v180, v244
  v_sub_f32 v181, v181, v244
  v_sub_f32 v182, v182, v244
  v_sub_f32 v183, v183, v244
  v_sub_f32 v160, v160, v244
  v_sub_f32 v161, v161, v244
  v_sub_f32 v162, v162, v244
  v_sub_f32 v163, v163, v244
  v_max_f32 v245, 0, v244
  v_exp_f32 v245, -v245
  s_nop 0
  v_mul_f32 v32, v245, v32
  v_mul_f32 v33, v245, v33
  v_mul_f32 v34, v245, v34
  v_mul_f32 v35, v245, v35
  v_mul_f32 v36, v245, v36
  v_mul_f32 v37, v245, v37
  v_mul_f32 v38, v245, v38
  v_mul_f32 v39, v245, v39
  v_mul_f32 v40, v245, v40
  v_mul_f32 v41, v245, v41
  v_mul_f32 v42, v245, v42
  v_mul_f32 v43, v245, v43
  v_mul_f32 v44, v245, v44
  v_mul_f32 v45, v245, v45
  v_mul_f32 v46, v245, v46
  v_mul_f32 v47, v245, v47
  v_mul_f32 v48, v245, v48
  v_mul_f32 v49, v245, v49
  v_mul_f32 v50, v245, v50
  v_mul_f32 v51, v245, v51
  v_mul_f32 v52, v245, v52
  v_mul_f32 v53, v245, v53
  v_mul_f32 v54, v245, v54
  v_mul_f32 v55, v245, v55
  v_mul_f32 v56, v245, v56
  v_mul_f32 v57, v245, v57
  v_mul_f32 v58, v245, v58
  v_mul_f32 v59, v245, v59
  v_mul_f32 v60, v245, v60
  v_mul_f32 v61, v245, v61
  v_mul_f32 v62, v245, v62
  v_mul_f32 v63, v245, v63
  v_mul_f32 v100, v245, v100
  v_mul_f32 v101, v245, v101
  v_mul_f32 v102, v245, v102
  v_mul_f32 v103, v245, v103
  s_mov_b32 s28, 0x41000000
  s_mov_b32 s29, 0
  s_branch RETM_1n
SLOWM_1e:
  v_lshrrev_b32 v248, 2, v252
  v_xor_b32 v249, 64, v248
  v_xor_b32 v250, 128, v248
  v_max3_f32 v244, v168, v169, v170
  v_max3_f32 v244, v244, v171, v172
  v_max3_f32 v244, v244, v173, v174
  v_max_f32 v244, v244, v175
  ds_bpermute_b32 v245, v249, v244
  s_waitcnt lgkmcnt(0)
  v_max_f32 v244, v244, v245
  ds_bpermute_b32 v245, v250, v244
  s_waitcnt lgkmcnt(0)
  v_max_f32 v244, v244, v245
  v_max_f32 v244, s29, v244
  v_sub_f32 v168, v168, v244
  v_sub_f32 v169, v169, v244
  v_sub_f32 v170, v170, v244
  v_sub_f32 v171, v171, v244
  v_sub_f32 v172, v172, v244
  v_sub_f32 v173, v173, v244
  v_sub_f32 v174, v174, v244
  v_sub_f32 v175, v175, v244
  v_sub_f32 v156, v156, v244
  v_sub_f32 v157, v157, v244
  v_sub_f32 v158, v158, v244
  v_sub_f32 v159, v159, v244
  v_max_f32 v245, 0, v244
  v_exp_f32 v245, -v245
  s_nop 0
  v_mul_f32 v0, v245, v0
  v_mul_f32 v1, v245, v1
  v_mul_f32 v2, v245, v2
  v_mul_f32 v3, v245, v3
  v_mul_f32 v4, v245, v4
  v_mul_f32 v5, v245, v5
  v_mul_f32 v6, v245, v6
  v_mul_f32 v7, v245, v7
  v_mul_f32 v8, v245, v8
  v_mul_f32 v9, v245, v9
  v_mul_f32 v10, v245, v10
  v_mul_f32 v11, v245, v11
  v_mul_f32 v12, v245, v12
  v_mul_f32 v13, v245, v13
  v_mul_f32 v14, v245, v14
  v_mul_f32 v15, v245, v15
  v_mul_f32 v16, v245, v16
  v_mul_f32 v17, v245, v17
  v_mul_f32 v18, v245, v18
  v_mul_f32 v19, v245, v19
  v_mul_f32 v20, v245, v20
  v_mul_f32 v21, v245, v21
  v_mul_f32 v22, v245, v22
  v_mul_f32 v23, v245, v23
  v_mul_f32 v24, v245, v24
  v_mul_f32 v25, v245, v25
  v_mul_f32 v26, v245, v26
  v_mul_f32 v27, v245, v27
  v_mul_f32 v28, v245, v28
  v_mul_f32 v29, v245, v29
  v_mul_f32 v30, v245, v30
  v_mul_f32 v31, v245, v31
  v_mul_f32 v96, v245, v96
  v_mul_f32 v97, v245, v97
  v_mul_f32 v98, v245, v98
  v_mul_f32 v99, v245, v99
  v_max3_f32 v244, v176, v177, v178
  v_max3_f32 v244, v244, v179, v180
  v_max3_f32 v244, v244, v181, v182
  v_max_f32 v244, v244, v183
  ds_bpermute_b32 v245, v249, v244
  s_waitcnt lgkmcnt(0)
  v_max_f32 v244, v244, v245
  ds_bpermute_b32 v245, v250, v244
  s_waitcnt lgkmcnt(0)
  v_max_f32 v244, v244, v245
  v_max_f32 v244, s29, v244
  v_sub_f32 v176, v176, v244
  v_sub_f32 v177, v177, v244
  v_sub_f32 v178, v178, v244
  v_sub_f32 v179, v179, v244
  v_sub_f32 v180, v180, v244
  v_sub_f32 v181, v181, v244
  v_sub_f32 v182, v182, v244
  v_sub_f32 v183, v183, v244
  v_sub_f32 v160, v160, v244
  v_sub_f32 v161, v161, v244
  v_sub_f32 v162, v162, v244
  v_sub_f32 v163, v163, v244
  v_max_f32 v245, 0, v244
  v_exp_f32 v245, -v245
  s_nop 0
  v_mul_f32 v32, v245, v32
  v_mul_f32 v33, v245, v33
  v_mul_f32 v34, v245, v34
  v_mul_f32 v35, v245, v35
  v_mul_f32 v36, v245, v36
  v_mul_f32 v37, v245, v37
  v_mul_f32 v38, v245, v38
  v_mul_f32 v39, v245, v39
  v_mul_f32 v40, v245, v40
  v_mul_f32 v41, v245, v41
  v_mul_f32 v42, v245, v42
  v_mul_f32 v43, v245, v43
  v_mul_f32 v44, v245, v44
  v_mul_f32 v45, v245, v45
  v_mul_f32 v46, v245, v46
  v_mul_f32 v47, v245, v47
  v_mul_f32 v48, v245, v48
  v_mul_f32 v49, v245, v49
  v_mul_f32 v50, v245, v50
  v_mul_f32 v51, v245, v51
  v_mul_f32 v52, v245, v52
  v_mul_f32 v53, v245, v53
  v_mul_f32 v54, v245, v54
  v_mul_f32 v55, v245, v55
  v_mul_f32 v56, v245, v56
  v_mul_f32 v57, v245, v57
  v_mul_f32 v58, v245, v58
  v_mul_f32 v59, v245, v59
  v_mul_f32 v60, v245, v60
  v_mul_f32 v61, v245, v61
  v_mul_f32 v62, v245, v62
  v_mul_f32 v63, v245, v63
  v_mul_f32 v100, v245, v100
  v_mul_f32 v101, v245, v101
  v_mul_f32 v102, v245, v102
  v_mul_f32 v103, v245, v103
  s_mov_b32 s28, 0x41000000
  s_mov_b32 s29, 0
  s_branch RETM_1e
SLOWE_1e:
  v_lshrrev_b32 v248, 2, v252
  v_xor_b32 v249, 64, v248
  v_xor_b32 v250, 128, v248
  v_max3_f32 v244, v184, v185, v186
  v_max3_f32 v244, v244, v187, v188
  v_max3_f32 v244, v244, v189, v190
  v_max_f32 v244, v244, v191
  ds_bpermute_b32 v245, v249, v244
  s_waitcnt lgkmcnt(0)
  v_max_f32 v244, v244, v245
  ds_bpermute_b32 v245, v250, v244
  s_waitcnt lgkmcnt(0)
  v_max_f32 v244, v244, v245
  v_max_f32 v244, s31, v244
  v_sub_f32 v184, v184, v244
  v_sub_f32 v185, v185, v244
  v_sub_f32 v186, v186, v244
  v_sub_f32 v187, v187, v244
  v_sub_f32 v188, v188, v244
  v_sub_f32 v189, v189, v244
  v_sub_f32 v190, v190, v244
  v_sub_f32 v191, v191, v244
  v_sub_f32 v164, v164, v244
  v_sub_f32 v165, v165, v244
  v_sub_f32 v166, v166, v244
  v_sub_f32 v167, v167, v244
  v_max_f32 v245, 0, v244
  v_exp_f32 v245, -v245
  s_nop 0
  v_mul_f32 v64, v245, v64
  v_mul_f32 v65, v245, v65
  v_mul_f32 v66, v245, v66
  v_mul_f32 v67, v245, v67
  v_mul_f32 v68, v245, v68
  v_mul_f32 v69, v245, v69
  v_mul_f32 v70, v245, v70
  v_mul_f32 v71, v245, v71
  v_mul_f32 v72, v245, v72
  v_mul_f32 v73, v245, v73
  v_mul_f32 v74, v245, v74
  v_mul_f32 v75, v245, v75
  v_mul_f32 v76, v245, v76
  v_mul_f32 v77, v245, v77
  v_mul_f32 v78, v245, v78
  v_mul_f32 v79, v245, v79
  v_mul_f32 v80, v245, v80
  v_mul_f32 v81, v245, v81
  v_mul_f32 v82, v245, v82
  v_mul_f32 v83, v245, v83
  v_mul_f32 v84, v245, v84
  v_mul_f32 v85, v245, v85
  v_mul_f32 v86, v245, v86
  v_mul_f32 v87, v245, v87
  v_mul_f32 v88, v245, v88
  v_mul_f32 v89, v245, v89
  v_mul_f32 v90, v245, v90
  v_mul_f32 v91, v245, v91
  v_mul_f32 v92, v245, v92
  v_mul_f32 v93, v245, v93
  v_mul_f32 v94, v245, v94
  v_mul_f32 v95, v245, v95
  v_mul_f32 v104, v245, v104
  v_mul_f32 v105, v245, v105
  v_mul_f32 v106, v245, v106
  v_mul_f32 v107, v245, v107
  s_mov_b32 s30, 0x41000000
  s_mov_b32 s31, 0
  s_branch RETE_1e
SLOWM_2n:
  v_lshrrev_b32 v248, 2, v252
  v_xor_b32 v249, 64, v248
  v_xor_b32 v250, 128, v248
  v_max3_f32 v244, v168, v169, v170
  v_max3_f32 v244, v244, v171, v172
  v_max3_f32 v244, v244, v173, v174
  v_max_f32 v244, v244, v175
  ds_bpermute_b32 v245, v249, v244
  s_waitcnt lgkmcnt(0)
  v_max_f32 v244, v244, v245
  ds_bpermute_b32 v245, v250, v244
  s_waitcnt lgkmcnt(0)
  v_max_f32 v244, v244, v245
  v_max_f32 v244, s29, v244
  v_sub_f32 v168, v168, v244
  v_sub_f32 v169, v169, v244
  v_sub_f32 v170, v170, v244
  v_sub_f32 v171, v171, v244
  v_sub_f32 v172, v172, v244
  v_sub_f32 v173, v173, v244
  v_sub_f32 v174, v174, v244
  v_sub_f32 v175, v175, v244
  v_sub_f32 v156, v156, v244
  v_sub_f32 v157, v157, v244
  v_sub_f32 v158, v158, v244
  v_sub_f32 v159, v159, v244
  v_max_f32 v245, 0, v244
  v_exp_f32 v245, -v245
  s_nop 0
  v_mul_f32 v0, v245, v0
  v_mul_f32 v1, v245, v1
  v_mul_f32 v2, v245, v2
  v_mul_f32 v3, v245, v3
  v_mul_f32 v4, v245, v4
  v_mul_f32 v5, v245, v5
  v_mul_f32 v6, v245, v6
  v_mul_f32 v7, v245, v7
  v_mul_f32 v8, v245, v8
  v_mul_f32 v9, v245, v9
  v_mul_f32 v10, v245, v10
  v_mul_f32 v11, v245, v11
  v_mul_f32 v12, v245, v12
  v_mul_f32 v13, v245, v13
  v_mul_f32 v14, v245, v14
  v_mul_f32 v15, v245, v15
  v_mul_f32 v16, v245, v16
  v_mul_f32 v17, v245, v17
  v_mul_f32 v18, v245, v18
  v_mul_f32 v19, v245, v19
  v_mul_f32 v20, v245, v20
  v_mul_f32 v21, v245, v21
  v_mul_f32 v22, v245, v22
  v_mul_f32 v23, v245, v23
  v_mul_f32 v24, v245, v24
  v_mul_f32 v25, v245, v25
  v_mul_f32 v26, v245, v26
  v_mul_f32 v27, v245, v27
  v_mul_f32 v28, v245, v28
  v_mul_f32 v29, v245, v29
  v_mul_f32 v30, v245, v30
  v_mul_f32 v31, v245, v31
  v_mul_f32 v96, v245, v96
  v_mul_f32 v97, v245, v97
  v_mul_f32 v98, v245, v98
  v_mul_f32 v99, v245, v99
  v_max3_f32 v244, v176, v177, v178
  v_max3_f32 v244, v244, v179, v180
  v_max3_f32 v244, v244, v181, v182
  v_max_f32 v244, v244, v183
  ds_bpermute_b32 v245, v249, v244
  s_waitcnt lgkmcnt(0)
  v_max_f32 v244, v244, v245
  ds_bpermute_b32 v245, v250, v244
  s_waitcnt lgkmcnt(0)
  v_max_f32 v244, v244, v245
  v_max_f32 v244, s29, v244
  v_sub_f32 v176, v176, v244
  v_sub_f32 v177, v177, v244
  v_sub_f32 v178, v178, v244
  v_sub_f32 v179, v179, v244
  v_sub_f32 v180, v180, v244
  v_sub_f32 v181, v181, v244
  v_sub_f32 v182, v182, v244
  v_sub_f32 v183, v183, v244
  v_sub_f32 v160, v160, v244
  v_sub_f32 v161, v161, v244
  v_sub_f32 v162, v162, v244
  v_sub_f32 v163, v163, v244
  v_max_f32 v245, 0, v244
  v_exp_f32 v245, -v245
  s_nop 0
  v_mul_f32 v32, v245, v32
  v_mul_f32 v33, v245, v33
  v_mul_f32 v34, v245, v34
  v_mul_f32 v35, v245, v35
  v_mul_f32 v36, v245, v36
  v_mul_f32 v37, v245, v37
  v_mul_f32 v38, v245, v38
  v_mul_f32 v39, v245, v39
  v_mul_f32 v40, v245, v40
  v_mul_f32 v41, v245, v41
  v_mul_f32 v42, v245, v42
  v_mul_f32 v43, v245, v43
  v_mul_f32 v44, v245, v44
  v_mul_f32 v45, v245, v45
  v_mul_f32 v46, v245, v46
  v_mul_f32 v47, v245, v47
  v_mul_f32 v48, v245, v48
  v_mul_f32 v49, v245, v49
  v_mul_f32 v50, v245, v50
  v_mul_f32 v51, v245, v51
  v_mul_f32 v52, v245, v52
  v_mul_f32 v53, v245, v53
  v_mul_f32 v54, v245, v54
  v_mul_f32 v55, v245, v55
  v_mul_f32 v56, v245, v56
  v_mul_f32 v57, v245, v57
  v_mul_f32 v58, v245, v58
  v_mul_f32 v59, v245, v59
  v_mul_f32 v60, v245, v60
  v_mul_f32 v61, v245, v61
  v_mul_f32 v62, v245, v62
  v_mul_f32 v63, v245, v63
  v_mul_f32 v100, v245, v100
  v_mul_f32 v101, v245, v101
  v_mul_f32 v102, v245, v102
  v_mul_f32 v103, v245, v103
  s_mov_b32 s28, 0x41000000
  s_mov_b32 s29, 0
  s_branch RETM_2n
SLOWM_2e:
  v_lshrrev_b32 v248, 2, v252
  v_xor_b32 v249, 64, v248
  v_xor_b32 v250, 128, v248
  v_max3_f32 v244, v168, v169, v170
  v_max3_f32 v244, v244, v171, v172
  v_max3_f32 v244, v244, v173, v174
  v_max_f32 v244, v244, v175
  ds_bpermute_b32 v245, v249, v244
  s_waitcnt lgkmcnt(0)
  v_max_f32 v244, v244, v245
  ds_bpermute_b32 v245, v250, v244
  s_waitcnt lgkmcnt(0)
  v_max_f32 v244, v244, v245
  v_max_f32 v244, s29, v244
  v_sub_f32 v168, v168, v244
  v_sub_f32 v169, v169, v244
  v_sub_f32 v170, v170, v244
  v_sub_f32 v171, v171, v244
  v_sub_f32 v172, v172, v244
  v_sub_f32 v173, v173, v244
  v_sub_f32 v174, v174, v244
  v_sub_f32 v175, v175, v244
  v_sub_f32 v156, v156, v244
  v_sub_f32 v157, v157, v244
  v_sub_f32 v158, v158, v244
  v_sub_f32 v159, v159, v244
  v_max_f32 v245, 0, v244
  v_exp_f32 v245, -v245
  s_nop 0
  v_mul_f32 v0, v245, v0
  v_mul_f32 v1, v245, v1
  v_mul_f32 v2, v245, v2
  v_mul_f32 v3, v245, v3
  v_mul_f32 v4, v245, v4
  v_mul_f32 v5, v245, v5
  v_mul_f32 v6, v245, v6
  v_mul_f32 v7, v245, v7
  v_mul_f32 v8, v245, v8
  v_mul_f32 v9, v245, v9
  v_mul_f32 v10, v245, v10
  v_mul_f32 v11, v245, v11
  v_mul_f32 v12, v245, v12
  v_mul_f32 v13, v245, v13
  v_mul_f32 v14, v245, v14
  v_mul_f32 v15, v245, v15
  v_mul_f32 v16, v245, v16
  v_mul_f32 v17, v245, v17
  v_mul_f32 v18, v245, v18
  v_mul_f32 v19, v245, v19
  v_mul_f32 v20, v245, v20
  v_mul_f32 v21, v245, v21
  v_mul_f32 v22, v245, v22
  v_mul_f32 v23, v245, v23
  v_mul_f32 v24, v245, v24
  v_mul_f32 v25, v245, v25
  v_mul_f32 v26, v245, v26
  v_mul_f32 v27, v245, v27
  v_mul_f32 v28, v245, v28
  v_mul_f32 v29, v245, v29
  v_mul_f32 v30, v245, v30
  v_mul_f32 v31, v245, v31
  v_mul_f32 v96, v245, v96
  v_mul_f32 v97, v245, v97
  v_mul_f32 v98, v245, v98
  v_mul_f32 v99, v245, v99
  v_max3_f32 v244, v176, v177, v178
  v_max3_f32 v244, v244, v179, v180
  v_max3_f32 v244, v244, v181, v182
  v_max_f32 v244, v244, v183
  ds_bpermute_b32 v245, v249, v244
  s_waitcnt lgkmcnt(0)
  v_max_f32 v244, v244, v245
  ds_bpermute_b32 v245, v250, v244
  s_waitcnt lgkmcnt(0)
  v_max_f32 v244, v244, v245
  v_max_f32 v244, s29, v244
  v_sub_f32 v176, v176, v244
  v_sub_f32 v177, v177, v244
  v_sub_f32 v178, v178, v244
  v_sub_f32 v179, v179, v244
  v_sub_f32 v180, v180, v244
  v_sub_f32 v181, v181, v244
  v_sub_f32 v182, v182, v244
  v_sub_f32 v183, v183, v244
  v_sub_f32 v160, v160, v244
  v_sub_f32 v161, v161, v244
  v_sub_f32 v162, v162, v244
  v_sub_f32 v163, v163, v244
  v_max_f32 v245, 0, v244
  v_exp_f32 v245, -v245
  s_nop 0
  v_mul_f32 v32, v245, v32
  v_mul_f32 v33, v245, v33
  v_mul_f32 v34, v245, v34
  v_mul_f32 v35, v245, v35
  v_mul_f32 v36, v245, v36
  v_mul_f32 v37, v245, v37
  v_mul_f32 v38, v245, v38
  v_mul_f32 v39, v245, v39
  v_mul_f32 v40, v245, v40
  v_mul_f32 v41, v245, v41
  v_mul_f32 v42, v245, v42
  v_mul_f32 v43, v245, v43
  v_mul_f32 v44, v245, v44
  v_mul_f32 v45, v245, v45
  v_mul_f32 v46, v245, v46
  v_mul_f32 v47, v245, v47
  v_mul_f32 v48, v245, v48
  v_mul_f32 v49, v245, v49
  v_mul_f32 v50, v245, v50
  v_mul_f32 v51, v245, v51
  v_mul_f32 v52, v245, v52
  v_mul_f32 v53, v245, v53
  v_mul_f32 v54, v245, v54
  v_mul_f32 v55, v245, v55
  v_mul_f32 v56, v245, v56
  v_mul_f32 v57, v245, v57
  v_mul_f32 v58, v245, v58
  v_mul_f32 v59, v245, v59
  v_mul_f32 v60, v245, v60
  v_mul_f32 v61, v245, v61
  v_mul_f32 v62, v245, v62
  v_mul_f32 v63, v245, v63
  v_mul_f32 v100, v245, v100
  v_mul_f32 v101, v245, v101
  v_mul_f32 v102, v245, v102
  v_mul_f32 v103, v245, v103
  s_mov_b32 s28, 0x41000000
  s_mov_b32 s29, 0
  s_branch RETM_2e
SLOWE_2e:
  v_lshrrev_b32 v248, 2, v252
  v_xor_b32 v249, 64, v248
  v_xor_b32 v250, 128, v248
  v_max3_f32 v244, v184, v185, v186
  v_max3_f32 v244, v244, v187, v188
  v_max3_f32 v244, v244, v189, v190
  v_max_f32 v244, v244, v191
  ds_bpermute_b32 v245, v249, v244
  s_waitcnt lgkmcnt(0)
  v_max_f32 v244, v244, v245
  ds_bpermute_b32 v245, v250, v244
  s_waitcnt lgkmcnt(0)
  v_max_f32 v244, v244, v245
  v_max_f32 v244, s31, v244
  v_sub_f32 v184, v184, v244
  v_sub_f32 v185, v185, v244
  v_sub_f32 v186, v186, v244
  v_sub_f32 v187, v187, v244
  v_sub_f32 v188, v188, v244
  v_sub_f32 v189, v189, v244
  v_sub_f32 v190, v190, v244
  v_sub_f32 v191, v191, v244
  v_sub_f32 v164, v164, v244
  v_sub_f32 v165, v165, v244
  v_sub_f32 v166, v166, v244
  v_sub_f32 v167, v167, v244
  v_max_f32 v245, 0, v244
  v_exp_f32 v245, -v245
  s_nop 0
  v_mul_f32 v64, v245, v64
  v_mul_f32 v65, v245, v65
  v_mul_f32 v66, v245, v66
  v_mul_f32 v67, v245, v67
  v_mul_f32 v68, v245, v68
  v_mul_f32 v69, v245, v69
  v_mul_f32 v70, v245, v70
  v_mul_f32 v71, v245, v71
  v_mul_f32 v72, v245, v72
  v_mul_f32 v73, v245, v73
  v_mul_f32 v74, v245, v74
  v_mul_f32 v75, v245, v75
  v_mul_f32 v76, v245, v76
  v_mul_f32 v77, v245, v77
  v_mul_f32 v78, v245, v78
  v_mul_f32 v79, v245, v79
  v_mul_f32 v80, v245, v80
  v_mul_f32 v81, v245, v81
  v_mul_f32 v82, v245, v82
  v_mul_f32 v83, v245, v83
  v_mul_f32 v84, v245, v84
  v_mul_f32 v85, v245, v85
  v_mul_f32 v86, v245, v86
  v_mul_f32 v87, v245, v87
  v_mul_f32 v88, v245, v88
  v_mul_f32 v89, v245, v89
  v_mul_f32 v90, v245, v90
  v_mul_f32 v91, v245, v91
  v_mul_f32 v92, v245, v92
  v_mul_f32 v93, v245, v93
  v_mul_f32 v94, v245, v94
  v_mul_f32 v95, v245, v95
  v_mul_f32 v104, v245, v104
  v_mul_f32 v105, v245, v105
  v_mul_f32 v106, v245, v106
  v_mul_f32 v107, v245, v107
  s_mov_b32 s30, 0x41000000
  s_mov_b32 s31, 0
  s_branch RETE_2e
SLOWM_3n:
  v_lshrrev_b32 v248, 2, v252
  v_xor_b32 v249, 64, v248
  v_xor_b32 v250, 128, v248
  v_max3_f32 v244, v168, v169, v170
  v_max3_f32 v244, v244, v171, v172
  v_max3_f32 v244, v244, v173, v174
  v_max_f32 v244, v244, v175
  ds_bpermute_b32 v245, v249, v244
  s_waitcnt lgkmcnt(0)
  v_max_f32 v244, v244, v245
  ds_bpermute_b32 v245, v250, v244
  s_waitcnt lgkmcnt(0)
  v_max_f32 v244, v244, v245
  v_max_f32 v244, s29, v244
  v_sub_f32 v168, v168, v244
  v_sub_f32 v169, v169, v244
  v_sub_f32 v170, v170, v244
  v_sub_f32 v171, v171, v244
  v_sub_f32 v172, v172, v244
  v_sub_f32 v173, v173, v244
  v_sub_f32 v174, v174, v244
  v_sub_f32 v175, v175, v244
  v_sub_f32 v156, v156, v244
  v_sub_f32 v157, v157, v244
  v_sub_f32 v158, v158, v244
  v_sub_f32 v159, v159, v244
  v_max_f32 v245, 0, v244
  v_exp_f32 v245, -v245
  s_nop 0
  v_mul_f32 v0, v245, v0
  v_mul_f32 v1, v245, v1
  v_mul_f32 v2, v245, v2
  v_mul_f32 v3, v245, v3
  v_mul_f32 v4, v245, v4
  v_mul_f32 v5, v245, v5
  v_mul_f32 v6, v245, v6
  v_mul_f32 v7, v245, v7
  v_mul_f32 v8, v245, v8
  v_mul_f32 v9, v245, v9
  v_mul_f32 v10, v245, v10
  v_mul_f32 v11, v245, v11
  v_mul_f32 v12, v245, v12
  v_mul_f32 v13, v245, v13
  v_mul_f32 v14, v245, v14
  v_mul_f32 v15, v245, v15
  v_mul_f32 v16, v245, v16
  v_mul_f32 v17, v245, v17
  v_mul_f32 v18, v245, v18
  v_mul_f32 v19, v245, v19
  v_mul_f32 v20, v245, v20
  v_mul_f32 v21, v245, v21
  v_mul_f32 v22, v245, v22
  v_mul_f32 v23, v245, v23
  v_mul_f32 v24, v245, v24
  v_mul_f32 v25, v245, v25
  v_mul_f32 v26, v245, v26
  v_mul_f32 v27, v245, v27
  v_mul_f32 v28, v245, v28
  v_mul_f32 v29, v245, v29
  v_mul_f32 v30, v245, v30
  v_mul_f32 v31, v245, v31
  v_mul_f32 v96, v245, v96
  v_mul_f32 v97, v245, v97
  v_mul_f32 v98, v245, v98
  v_mul_f32 v99, v245, v99
  v_max3_f32 v244, v176, v177, v178
  v_max3_f32 v244, v244, v179, v180
  v_max3_f32 v244, v244, v181, v182
  v_max_f32 v244, v244, v183
  ds_bpermute_b32 v245, v249, v244
  s_waitcnt lgkmcnt(0)
  v_max_f32 v244, v244, v245
  ds_bpermute_b32 v245, v250, v244
  s_waitcnt lgkmcnt(0)
  v_max_f32 v244, v244, v245
  v_max_f32 v244, s29, v244
  v_sub_f32 v176, v176, v244
  v_sub_f32 v177, v177, v244
  v_sub_f32 v178, v178, v244
  v_sub_f32 v179, v179, v244
  v_sub_f32 v180, v180, v244
  v_sub_f32 v181, v181, v244
  v_sub_f32 v182, v182, v244
  v_sub_f32 v183, v183, v244
  v_sub_f32 v160, v160, v244
  v_sub_f32 v161, v161, v244
  v_sub_f32 v162, v162, v244
  v_sub_f32 v163, v163, v244
  v_max_f32 v245, 0, v244
  v_exp_f32 v245, -v245
  s_nop 0
  v_mul_f32 v32, v245, v32
  v_mul_f32 v33, v245, v33
  v_mul_f32 v34, v245, v34
  v_mul_f32 v35, v245, v35
  v_mul_f32 v36, v245, v36
  v_mul_f32 v37, v245, v37
  v_mul_f32 v38, v245, v38
  v_mul_f32 v39, v245, v39
  v_mul_f32 v40, v245, v40
  v_mul_f32 v41, v245, v41
  v_mul_f32 v42, v245, v42
  v_mul_f32 v43, v245, v43
  v_mul_f32 v44, v245, v44
  v_mul_f32 v45, v245, v45
  v_mul_f32 v46, v245, v46
  v_mul_f32 v47, v245, v47
  v_mul_f32 v48, v245, v48
  v_mul_f32 v49, v245, v49
  v_mul_f32 v50, v245, v50
  v_mul_f32 v51, v245, v51
  v_mul_f32 v52, v245, v52
  v_mul_f32 v53, v245, v53
  v_mul_f32 v54, v245, v54
  v_mul_f32 v55, v245, v55
  v_mul_f32 v56, v245, v56
  v_mul_f32 v57, v245, v57
  v_mul_f32 v58, v245, v58
  v_mul_f32 v59, v245, v59
  v_mul_f32 v60, v245, v60
  v_mul_f32 v61, v245, v61
  v_mul_f32 v62, v245, v62
  v_mul_f32 v63, v245, v63
  v_mul_f32 v100, v245, v100
  v_mul_f32 v101, v245, v101
  v_mul_f32 v102, v245, v102
  v_mul_f32 v103, v245, v103
  s_mov_b32 s28, 0x41000000
  s_mov_b32 s29, 0
  s_branch RETM_3n
SLOWM_3e:
  v_lshrrev_b32 v248, 2, v252
  v_xor_b32 v249, 64, v248
  v_xor_b32 v250, 128, v248
  v_max3_f32 v244, v168, v169, v170
  v_max3_f32 v244, v244, v171, v172
  v_max3_f32 v244, v244, v173, v174
  v_max_f32 v244, v244, v175
  ds_bpermute_b32 v245, v249, v244
  s_waitcnt lgkmcnt(0)
  v_max_f32 v244, v244, v245
  ds_bpermute_b32 v245, v250, v244
  s_waitcnt lgkmcnt(0)
  v_max_f32 v244, v244, v245
  v_max_f32 v244, s29, v244
  v_sub_f32 v168, v168, v244
  v_sub_f32 v169, v169, v244
  v_sub_f32 v170, v170, v244
  v_sub_f32 v171, v171, v244
  v_sub_f32 v172, v172, v244
  v_sub_f32 v173, v173, v244
  v_sub_f32 v174, v174, v244
  v_sub_f32 v175, v175, v244
  v_sub_f32 v156, v156, v244
  v_sub_f32 v157, v157, v244
  v_sub_f32 v158, v158, v244
  v_sub_f32 v159, v159, v244
  v_max_f32 v245, 0, v244
  v_exp_f32 v245, -v245
  s_nop 0
  v_mul_f32 v0, v245, v0
  v_mul_f32 v1, v245, v1
  v_mul_f32 v2, v245, v2
  v_mul_f32 v3, v245, v3
  v_mul_f32 v4, v245, v4
  v_mul_f32 v5, v245, v5
  v_mul_f32 v6, v245, v6
  v_mul_f32 v7, v245, v7
  v_mul_f32 v8, v245, v8
  v_mul_f32 v9, v245, v9
  v_mul_f32 v10, v245, v10
  v_mul_f32 v11, v245, v11
  v_mul_f32 v12, v245, v12
  v_mul_f32 v13, v245, v13
  v_mul_f32 v14, v245, v14
  v_mul_f32 v15, v245, v15
  v_mul_f32 v16, v245, v16
  v_mul_f32 v17, v245, v17
  v_mul_f32 v18, v245, v18
  v_mul_f32 v19, v245, v19
  v_mul_f32 v20, v245, v20
  v_mul_f32 v21, v245, v21
  v_mul_f32 v22, v245, v22
  v_mul_f32 v23, v245, v23
  v_mul_f32 v24, v245, v24
  v_mul_f32 v25, v245, v25
  v_mul_f32 v26, v245, v26
  v_mul_f32 v27, v245, v27
  v_mul_f32 v28, v245, v28
  v_mul_f32 v29, v245, v29
  v_mul_f32 v30, v245, v30
  v_mul_f32 v31, v245, v31
  v_mul_f32 v96, v245, v96
  v_mul_f32 v97, v245, v97
  v_mul_f32 v98, v245, v98
  v_mul_f32 v99, v245, v99
  v_max3_f32 v244, v176, v177, v178
  v_max3_f32 v244, v244, v179, v180
  v_max3_f32 v244, v244, v181, v182
  v_max_f32 v244, v244, v183
  ds_bpermute_b32 v245, v249, v244
  s_waitcnt lgkmcnt(0)
  v_max_f32 v244, v244, v245
  ds_bpermute_b32 v245, v250, v244
  s_waitcnt lgkmcnt(0)
  v_max_f32 v244, v244, v245
  v_max_f32 v244, s29, v244
  v_sub_f32 v176, v176, v244
  v_sub_f32 v177, v177, v244
  v_sub_f32 v178, v178, v244
  v_sub_f32 v179, v179, v244
  v_sub_f32 v180, v180, v244
  v_sub_f32 v181, v181, v244
  v_sub_f32 v182, v182, v244
  v_sub_f32 v183, v183, v244
  v_sub_f32 v160, v160, v244
  v_sub_f32 v161, v161, v244
  v_sub_f32 v162, v162, v244
  v_sub_f32 v163, v163, v244
  v_max_f32 v245, 0, v244
  v_exp_f32 v245, -v245
  s_nop 0
  v_mul_f32 v32, v245, v32
  v_mul_f32 v33, v245, v33
  v_mul_f32 v34, v245, v34
  v_mul_f32 v35, v245, v35
  v_mul_f32 v36, v245, v36
  v_mul_f32 v37, v245, v37
  v_mul_f32 v38, v245, v38
  v_mul_f32 v39, v245, v39
  v_mul_f32 v40, v245, v40
  v_mul_f32 v41, v245, v41
  v_mul_f32 v42, v245, v42
  v_mul_f32 v43, v245, v43
  v_mul_f32 v44, v245, v44
  v_mul_f32 v45, v245, v45
  v_mul_f32 v46, v245, v46
  v_mul_f32 v47, v245, v47
  v_mul_f32 v48, v245, v48
  v_mul_f32 v49, v245, v49
  v_mul_f32 v50, v245, v50
  v_mul_f32 v51, v245, v51
  v_mul_f32 v52, v245, v52
  v_mul_f32 v53, v245, v53
  v_mul_f32 v54, v245, v54
  v_mul_f32 v55, v245, v55
  v_mul_f32 v56, v245, v56
  v_mul_f32 v57, v245, v57
  v_mul_f32 v58, v245, v58
  v_mul_f32 v59, v245, v59
  v_mul_f32 v60, v245, v60
  v_mul_f32 v61, v245, v61
  v_mul_f32 v62, v245, v62
  v_mul_f32 v63, v245, v63
  v_mul_f32 v100, v245, v100
  v_mul_f32 v101, v245, v101
  v_mul_f32 v102, v245, v102
  v_mul_f32 v103, v245, v103
  s_mov_b32 s28, 0x41000000
  s_mov_b32 s29, 0
  s_branch RETM_3e
SLOWE_3e:
  v_lshrrev_b32 v248, 2, v252
  v_xor_b32 v249, 64, v248
  v_xor_b32 v250, 128, v248
  v_max3_f32 v244, v184, v185, v186
  v_max3_f32 v244, v244, v187, v188
  v_max3_f32 v244, v244, v189, v190
  v_max_f32 v244, v244, v191
  ds_bpermute_b32 v245, v249, v244
  s_waitcnt lgkmcnt(0)
  v_max_f32 v244, v244, v245
  ds_bpermute_b32 v245, v250, v244
  s_waitcnt lgkmcnt(0)
  v_max_f32 v244, v244, v245
  v_max_f32 v244, s31, v244
  v_sub_f32 v184, v184, v244
  v_sub_f32 v185, v185, v244
  v_sub_f32 v186, v186, v244
  v_sub_f32 v187, v187, v244
  v_sub_f32 v188, v188, v244
  v_sub_f32 v189, v189, v244
  v_sub_f32 v190, v190, v244
  v_sub_f32 v191, v191, v244
  v_sub_f32 v164, v164, v244
  v_sub_f32 v165, v165, v244
  v_sub_f32 v166, v166, v244
  v_sub_f32 v167, v167, v244
  v_max_f32 v245, 0, v244
  v_exp_f32 v245, -v245
  s_nop 0
  v_mul_f32 v64, v245, v64
  v_mul_f32 v65, v245, v65
  v_mul_f32 v66, v245, v66
  v_mul_f32 v67, v245, v67
  v_mul_f32 v68, v245, v68
  v_mul_f32 v69, v245, v69
  v_mul_f32 v70, v245, v70
  v_mul_f32 v71, v245, v71
  v_mul_f32 v72, v245, v72
  v_mul_f32 v73, v245, v73
  v_mul_f32 v74, v245, v74
  v_mul_f32 v75, v245, v75
  v_mul_f32 v76, v245, v76
  v_mul_f32 v77, v245, v77
  v_mul_f32 v78, v245, v78
  v_mul_f32 v79, v245, v79
  v_mul_f32 v80, v245, v80
  v_mul_f32 v81, v245, v81
  v_mul_f32 v82, v245, v82
  v_mul_f32 v83, v245, v83
  v_mul_f32 v84, v245, v84
  v_mul_f32 v85, v245, v85
  v_mul_f32 v86, v245, v86
  v_mul_f32 v87, v245, v87
  v_mul_f32 v88, v245, v88
  v_mul_f32 v89, v245, v89
  v_mul_f32 v90, v245, v90
  v_mul_f32 v91, v245, v91
  v_mul_f32 v92, v245, v92
  v_mul_f32 v93, v245, v93
  v_mul_f32 v94, v245, v94
  v_mul_f32 v95, v245, v95
  v_mul_f32 v104, v245, v104
  v_mul_f32 v105, v245, v105
  v_mul_f32 v106, v245, v106
  v_mul_f32 v107, v245, v107
  s_mov_b32 s30, 0x41000000
  s_mov_b32 s31, 0
  s_branch RETE_3e
.globl oproj_kernel
.p2align 8
.type oproj_kernel,@function
oproj_kernel:
  s_cmp_ge_u32 s2, 256
  s_cbranch_scc1 K2_END
  s_and_b32 s33, s2, 7
  s_lshr_b32 s34, s2, 3
  s_lshr_b32 s35, s33, 2
  s_and_b32 s36, s33, 3
  s_lshl_b32 s36, s36, 1
  s_lshr_b32 s37, s34, 4
  s_add_u32 s36, s36, s37
  s_lshr_b32 s37, s34, 3
  s_and_b32 s37, s37, 1
  s_and_b32 s38, s34, 7
  s_mul_i32 s39, s35, 40
  s_add_u32 s40, s0, s39
  s_addc_u32 s41, s1, 0
  s_load_dwordx2 s[44:45], s[40:41], 32
  s_load_dwordx2 s[46:47], s[0:1], 80
  s_load_dwordx2 s[48:49], s[0:1], 96
  v_lshrrev_b32 v1, 6, v0
  v_and_b32 v2, 63, v0
  v_readfirstlane_b32 s24, v1
  v_lshrrev_b32 v3, 4, v2
  v_and_b32 v4, 15, v2
  v_lshlrev_b32 v202, 4, v2
  s_lshl_b32 s42, s24, 15
  v_add_u32 v196, s42, v202
  s_lshl_b32 s42, s24, 20
  v_lshrrev_b32 v5, 3, v2
  v_lshlrev_b32 v5, 10, v5
  v_and_b32 v6, 7, v2
  v_lshlrev_b32 v7, 1, v3
  v_xor_b32 v6, v6, v7
  v_lshl_add_u32 v5, v6, 4, v5
  v_add_u32 v201, s42, v5
  s_mul_i32 s43, s24, 24576
  v_lshrrev_b32 v5, 2, v4
  v_lshl_add_u32 v5, v3, 2, v5
  v_bfe_u32 v6, v5, 1, 2
  v_bfe_u32 v7, v4, 1, 1
  v_lshlrev_b32 v7, 4, v7
  v_and_b32 v8, 1, v4
  v_lshl_add_u32 v7, v8, 3, v7
  v_lshl_add_u32 v7, v5, 7, v7
  v_add_u32 v7, s43, v7
  v_xor_b32 v8, 0, v6
  v_lshl_add_u32 v192, v8, 5, v7
  v_xor_b32 v8, 1, v6
  v_lshl_add_u32 v193, v8, 5, v7
  v_xor_b32 v8, 2, v6
  v_lshl_add_u32 v194, v8, 5, v7
  v_xor_b32 v8, 3, v6
  v_lshl_add_u32 v195, v8, 5, v7
  s_waitcnt lgkmcnt(0)
  s_lshl_b32 s42, s38, 7
  s_add_u32 s4, s44, s42
  s_addc_u32 s5, s45, 0
  s_sub_u32 s6, 0x400000, s42
  s_mov_b32 s7, 0x00020000
  s_lshl_b32 s42, s35, 3
  s_add_u32 s42, s42, s36
  s_mul_i32 s42, s42, 9
  s_mul_i32 s33, s37, 4
  s_add_u32 s42, s42, s33
  s_lshl_b32 s42, s42, 17
  s_add_u32 s8, s48, s42
  s_addc_u32 s9, s49, 0
  s_mov_b32 s10, 655360
  s_mov_b32 s11, 0x00020000
  s_mul_i32 s42, s36, 144
  s_mul_i32 s33, s37, 64
  s_add_u32 s42, s42, s33
  s_lshl_b32 s42, s42, 11
  s_lshl_b32 s33, s35, 10
  s_add_u32 s42, s42, s33
  s_lshl_b32 s33, s38, 7
  s_add_u32 s42, s42, s33
  s_add_u32 s12, s46, s42
  s_addc_u32 s13, s47, 0
  s_mov_b32 s14, 161920
  s_mov_b32 s15, 0x00020000
  v_add_u32 v197, 131072, v196
  v_add_u32 v198, 262144, v196
  v_add_u32 v199, 393216, v196
  v_add_u32 v200, 524288, v196
  s_and_b32 s33, s36, 1
  s_lshl_b32 s33, s33, 1
  s_add_u32 s33, s33, s37
  s_lshl_b32 s33, s33, 3
  s_lshl_b32 s16, s38, 2
  s_add_u32 s16, s16, s33
  s_mov_b32 s16, 0
  s_add_u32 s17, s16, 0
  s_and_b32 s17, s17, 31
  s_lshl_b32 s17, s17, 15
  s_add_u32 m0, s43, 0x0
  s_add_u32 s33, s17, 0x0
  buffer_load_dwordx4 v201, s[4:7], s33 offen lds
  s_add_u32 m0, s43, 0x400
  s_add_u32 s33, s17, 0x2000
  buffer_load_dwordx4 v201, s[4:7], s33 offen lds
  s_add_u32 m0, s43, 0x800
  s_add_u32 s33, s17, 0x4000
  buffer_load_dwordx4 v201, s[4:7], s33 offen lds
  s_add_u32 m0, s43, 0xc00
  s_add_u32 s33, s17, 0x6000
  buffer_load_dwordx4 v201, s[4:7], s33 offen lds
  s_add_u32 s18, s16, 0
  s_and_b32 s18, s18, 31
  s_lshl_b32 s18, s18, 10
  buffer_load_dwordx4 v[80:83], v196, s[8:11], s18 offen
  buffer_load_dwordx4 v[84:87], v197, s[8:11], s18 offen
  buffer_load_dwordx4 v[88:91], v198, s[8:11], s18 offen
  buffer_load_dwordx4 v[92:95], v199, s[8:11], s18 offen
  buffer_load_dwordx4 v[96:99], v200, s[8:11], s18 offen
  s_add_u32 s17, s16, 1
  s_and_b32 s17, s17, 31
  s_lshl_b32 s17, s17, 15
  s_add_u32 m0, s43, 0x1000
  s_add_u32 s33, s17, 0x0
  buffer_load_dwordx4 v201, s[4:7], s33 offen lds
  s_add_u32 m0, s43, 0x1400
  s_add_u32 s33, s17, 0x2000
  buffer_load_dwordx4 v201, s[4:7], s33 offen lds
  s_add_u32 m0, s43, 0x1800
  s_add_u32 s33, s17, 0x4000
  buffer_load_dwordx4 v201, s[4:7], s33 offen lds
  s_add_u32 m0, s43, 0x1c00
  s_add_u32 s33, s17, 0x6000
  buffer_load_dwordx4 v201, s[4:7], s33 offen lds
  s_add_u32 s18, s16, 1
  s_and_b32 s18, s18, 31
  s_lshl_b32 s18, s18, 10
  buffer_load_dwordx4 v[100:103], v196, s[8:11], s18 offen
  buffer_load_dwordx4 v[104:107], v197, s[8:11], s18 offen
  buffer_load_dwordx4 v[108:111], v198, s[8:11], s18 offen
  buffer_load_dwordx4 v[112:115], v199, s[8:11], s18 offen
  buffer_load_dwordx4 v[116:119], v200, s[8:11], s18 offen
  s_add_u32 s17, s16, 2
  s_and_b32 s17, s17, 31
  s_lshl_b32 s17, s17, 15
  s_add_u32 m0, s43, 0x2000
  s_add_u32 s33, s17, 0x0
  buffer_load_dwordx4 v201, s[4:7], s33 offen lds
  s_add_u32 m0, s43, 0x2400
  s_add_u32 s33, s17, 0x2000
  buffer_load_dwordx4 v201, s[4:7], s33 offen lds
  s_add_u32 m0, s43, 0x2800
  s_add_u32 s33, s17, 0x4000
  buffer_load_dwordx4 v201, s[4:7], s33 offen lds
  s_add_u32 m0, s43, 0x2c00
  s_add_u32 s33, s17, 0x6000
  buffer_load_dwordx4 v201, s[4:7], s33 offen lds
  s_add_u32 s18, s16, 2
  s_and_b32 s18, s18, 31
  s_lshl_b32 s18, s18, 10
  buffer_load_dwordx4 v[120:123], v196, s[8:11], s18 offen
  buffer_load_dwordx4 v[124:127], v197, s[8:11], s18 offen
  buffer_load_dwordx4 v[128:131], v198, s[8:11], s18 offen
  buffer_load_dwordx4 v[132:135], v199, s[8:11], s18 offen
  buffer_load_dwordx4 v[136:139], v200, s[8:11], s18 offen
  s_add_u32 s17, s16, 3
  s_and_b32 s17, s17, 31
  s_lshl_b32 s17, s17, 15
  s_add_u32 m0, s43, 0x3000
  s_add_u32 s33, s17, 0x0
  buffer_load_dwordx4 v201, s[4:7], s33 offen lds
  s_add_u32 m0, s43, 0x3400
  s_add_u32 s33, s17, 0x2000
  buffer_load_dwordx4 v201, s[4:7], s33 offen lds
  s_add_u32 m0, s43, 0x3800
  s_add_u32 s33, s17, 0x4000
  buffer_load_dwordx4 v201, s[4:7], s33 offen lds
  s_add_u32 m0, s43, 0x3c00
  s_add_u32 s33, s17, 0x6000
  buffer_load_dwordx4 v201, s[4:7], s33 offen lds
  s_add_u32 s18, s16, 3
  s_and_b32 s18, s18, 31
  s_lshl_b32 s18, s18, 10
  buffer_load_dwordx4 v[140:143], v196, s[8:11], s18 offen
  buffer_load_dwordx4 v[144:147], v197, s[8:11], s18 offen
  buffer_load_dwordx4 v[148:151], v198, s[8:11], s18 offen
  buffer_load_dwordx4 v[152:155], v199, s[8:11], s18 offen
  buffer_load_dwordx4 v[156:159], v200, s[8:11], s18 offen
  s_add_u32 s17, s16, 4
  s_and_b32 s17, s17, 31
  s_lshl_b32 s17, s17, 15
  s_add_u32 m0, s43, 0x4000
  s_add_u32 s33, s17, 0x0
  buffer_load_dwordx4 v201, s[4:7], s33 offen lds
  s_add_u32 m0, s43, 0x4400
  s_add_u32 s33, s17, 0x2000
  buffer_load_dwordx4 v201, s[4:7], s33 offen lds
  s_add_u32 m0, s43, 0x4800
  s_add_u32 s33, s17, 0x4000
  buffer_load_dwordx4 v201, s[4:7], s33 offen lds
  s_add_u32 m0, s43, 0x4c00
  s_add_u32 s33, s17, 0x6000
  buffer_load_dwordx4 v201, s[4:7], s33 offen lds
  s_waitcnt vmcnt(36)
  ds_read_b64_tr_b16 v[160:161], v192 offset:0
  ds_read_b64_tr_b16 v[162:163], v192 offset:2048
  ds_read_b64_tr_b16 v[164:165], v193 offset:0
  ds_read_b64_tr_b16 v[166:167], v193 offset:2048
  ds_read_b64_tr_b16 v[168:169], v194 offset:0
  ds_read_b64_tr_b16 v[170:171], v194 offset:2048
  ds_read_b64_tr_b16 v[172:173], v195 offset:0
  ds_read_b64_tr_b16 v[174:175], v195 offset:2048
  s_waitcnt vmcnt(27)
  ds_read_b64_tr_b16 v[176:177], v192 offset:4096
  ds_read_b64_tr_b16 v[178:179], v192 offset:6144
  ds_read_b64_tr_b16 v[180:181], v193 offset:4096
  ds_read_b64_tr_b16 v[182:183], v193 offset:6144
  ds_read_b64_tr_b16 v[184:185], v194 offset:4096
  ds_read_b64_tr_b16 v[186:187], v194 offset:6144
  ds_read_b64_tr_b16 v[188:189], v195 offset:4096
  ds_read_b64_tr_b16 v[190:191], v195 offset:6144
  s_waitcnt lgkmcnt(8)
  s_add_u32 s17, s16, 5
  s_and_b32 s17, s17, 31
  s_lshl_b32 s17, s17, 15
  s_add_u32 m0, s43, 0x5000
  s_add_u32 s33, s17, 0x0
  buffer_load_dwordx4 v201, s[4:7], s33 offen lds
  s_add_u32 m0, s43, 0x5400
  s_add_u32 s33, s17, 0x2000
  buffer_load_dwordx4 v201, s[4:7], s33 offen lds
  s_add_u32 m0, s43, 0x5800
  s_add_u32 s33, s17, 0x4000
  buffer_load_dwordx4 v201, s[4:7], s33 offen lds
  s_add_u32 m0, s43, 0x5c00
  s_add_u32 s33, s17, 0x6000
  buffer_load_dwordx4 v201, s[4:7], s33 offen lds
  v_mfma_f32_16x16x32_bf16 v[0:3], v[160:163], v[80:83], 0
  v_mfma_f32_16x16x32_bf16 v[4:7], v[160:163], v[84:87], 0
  v_mfma_f32_16x16x32_bf16 v[8:11], v[160:163], v[88:91], 0
  v_mfma_f32_16x16x32_bf16 v[12:15], v[160:163], v[92:95], 0
  v_mfma_f32_16x16x32_bf16 v[16:19], v[160:163], v[96:99], 0
  v_mfma_f32_16x16x32_bf16 v[20:23], v[164:167], v[80:83], 0
  v_mfma_f32_16x16x32_bf16 v[24:27], v[164:167], v[84:87], 0
  v_mfma_f32_16x16x32_bf16 v[28:31], v[164:167], v[88:91], 0
  v_mfma_f32_16x16x32_bf16 v[32:35], v[164:167], v[92:95], 0
  v_mfma_f32_16x16x32_bf16 v[36:39], v[164:167], v[96:99], 0
  v_mfma_f32_16x16x32_bf16 v[40:43], v[168:171], v[80:83], 0
  v_mfma_f32_16x16x32_bf16 v[44:47], v[168:171], v[84:87], 0
  v_mfma_f32_16x16x32_bf16 v[48:51], v[168:171], v[88:91], 0
  v_mfma_f32_16x16x32_bf16 v[52:55], v[168:171], v[92:95], 0
  v_mfma_f32_16x16x32_bf16 v[56:59], v[168:171], v[96:99], 0
  v_mfma_f32_16x16x32_bf16 v[60:63], v[172:175], v[80:83], 0
  v_mfma_f32_16x16x32_bf16 v[64:67], v[172:175], v[84:87], 0
  v_mfma_f32_16x16x32_bf16 v[68:71], v[172:175], v[88:91], 0
  v_mfma_f32_16x16x32_bf16 v[72:75], v[172:175], v[92:95], 0
  v_mfma_f32_16x16x32_bf16 v[76:79], v[172:175], v[96:99], 0
  s_add_u32 s18, s16, 4
  s_and_b32 s18, s18, 31
  s_lshl_b32 s18, s18, 10
  buffer_load_dwordx4 v[80:83], v196, s[8:11], s18 offen
  buffer_load_dwordx4 v[84:87], v197, s[8:11], s18 offen
  buffer_load_dwordx4 v[88:91], v198, s[8:11], s18 offen
  buffer_load_dwordx4 v[92:95], v199, s[8:11], s18 offen
  buffer_load_dwordx4 v[96:99], v200, s[8:11], s18 offen
  s_waitcnt vmcnt(27)
  ds_read_b64_tr_b16 v[160:161], v192 offset:8192
  ds_read_b64_tr_b16 v[162:163], v192 offset:10240
  ds_read_b64_tr_b16 v[164:165], v193 offset:8192
  ds_read_b64_tr_b16 v[166:167], v193 offset:10240
  ds_read_b64_tr_b16 v[168:169], v194 offset:8192
  ds_read_b64_tr_b16 v[170:171], v194 offset:10240
  ds_read_b64_tr_b16 v[172:173], v195 offset:8192
  ds_read_b64_tr_b16 v[174:175], v195 offset:10240
  s_waitcnt lgkmcnt(8)
  s_add_u32 s17, s16, 6
  s_and_b32 s17, s17, 31
  s_lshl_b32 s17, s17, 15
  s_add_u32 m0, s43, 0x0
  s_add_u32 s33, s17, 0x0
  buffer_load_dwordx4 v201, s[4:7], s33 offen lds
  s_add_u32 m0, s43, 0x400
  s_add_u32 s33, s17, 0x2000
  buffer_load_dwordx4 v201, s[4:7], s33 offen lds
  s_add_u32 m0, s43, 0x800
  s_add_u32 s33, s17, 0x4000
  buffer_load_dwordx4 v201, s[4:7], s33 offen lds
  s_add_u32 m0, s43, 0xc00
  s_add_u32 s33, s17, 0x6000
  buffer_load_dwordx4 v201, s[4:7], s33 offen lds
  v_mfma_f32_16x16x32_bf16 v[0:3], v[176:179], v[100:103], v[0:3]
  v_mfma_f32_16x16x32_bf16 v[4:7], v[176:179], v[104:107], v[4:7]
  v_mfma_f32_16x16x32_bf16 v[8:11], v[176:179], v[108:111], v[8:11]
  v_mfma_f32_16x16x32_bf16 v[12:15], v[176:179], v[112:115], v[12:15]
  v_mfma_f32_16x16x32_bf16 v[16:19], v[176:179], v[116:119], v[16:19]
  v_mfma_f32_16x16x32_bf16 v[20:23], v[180:183], v[100:103], v[20:23]
  v_mfma_f32_16x16x32_bf16 v[24:27], v[180:183], v[104:107], v[24:27]
  v_mfma_f32_16x16x32_bf16 v[28:31], v[180:183], v[108:111], v[28:31]
  v_mfma_f32_16x16x32_bf16 v[32:35], v[180:183], v[112:115], v[32:35]
  v_mfma_f32_16x16x32_bf16 v[36:39], v[180:183], v[116:119], v[36:39]
  v_mfma_f32_16x16x32_bf16 v[40:43], v[184:187], v[100:103], v[40:43]
  v_mfma_f32_16x16x32_bf16 v[44:47], v[184:187], v[104:107], v[44:47]
  v_mfma_f32_16x16x32_bf16 v[48:51], v[184:187], v[108:111], v[48:51]
  v_mfma_f32_16x16x32_bf16 v[52:55], v[184:187], v[112:115], v[52:55]
  v_mfma_f32_16x16x32_bf16 v[56:59], v[184:187], v[116:119], v[56:59]
  v_mfma_f32_16x16x32_bf16 v[60:63], v[188:191], v[100:103], v[60:63]
  v_mfma_f32_16x16x32_bf16 v[64:67], v[188:191], v[104:107], v[64:67]
  v_mfma_f32_16x16x32_bf16 v[68:71], v[188:191], v[108:111], v[68:71]
  v_mfma_f32_16x16x32_bf16 v[72:75], v[188:191], v[112:115], v[72:75]
  v_mfma_f32_16x16x32_bf16 v[76:79], v[188:191], v[116:119], v[76:79]
  s_add_u32 s18, s16, 5
  s_and_b32 s18, s18, 31
  s_lshl_b32 s18, s18, 10
  buffer_load_dwordx4 v[100:103], v196, s[8:11], s18 offen
  buffer_load_dwordx4 v[104:107], v197, s[8:11], s18 offen
  buffer_load_dwordx4 v[108:111], v198, s[8:11], s18 offen
  buffer_load_dwordx4 v[112:115], v199, s[8:11], s18 offen
  buffer_load_dwordx4 v[116:119], v200, s[8:11], s18 offen
  s_waitcnt vmcnt(27)
  ds_read_b64_tr_b16 v[176:177], v192 offset:12288
  ds_read_b64_tr_b16 v[178:179], v192 offset:14336
  ds_read_b64_tr_b16 v[180:181], v193 offset:12288
  ds_read_b64_tr_b16 v[182:183], v193 offset:14336
  ds_read_b64_tr_b16 v[184:185], v194 offset:12288
  ds_read_b64_tr_b16 v[186:187], v194 offset:14336
  ds_read_b64_tr_b16 v[188:189], v195 offset:12288
  ds_read_b64_tr_b16 v[190:191], v195 offset:14336
  s_waitcnt lgkmcnt(8)
  s_add_u32 s17, s16, 7
  s_and_b32 s17, s17, 31
  s_lshl_b32 s17, s17, 15
  s_add_u32 m0, s43, 0x1000
  s_add_u32 s33, s17, 0x0
  buffer_load_dwordx4 v201, s[4:7], s33 offen lds
  s_add_u32 m0, s43, 0x1400
  s_add_u32 s33, s17, 0x2000
  buffer_load_dwordx4 v201, s[4:7], s33 offen lds
  s_add_u32 m0, s43, 0x1800
  s_add_u32 s33, s17, 0x4000
  buffer_load_dwordx4 v201, s[4:7], s33 offen lds
  s_add_u32 m0, s43, 0x1c00
  s_add_u32 s33, s17, 0x6000
  buffer_load_dwordx4 v201, s[4:7], s33 offen lds
  v_mfma_f32_16x16x32_bf16 v[0:3], v[160:163], v[120:123], v[0:3]
  v_mfma_f32_16x16x32_bf16 v[4:7], v[160:163], v[124:127], v[4:7]
  v_mfma_f32_16x16x32_bf16 v[8:11], v[160:163], v[128:131], v[8:11]
  v_mfma_f32_16x16x32_bf16 v[12:15], v[160:163], v[132:135], v[12:15]
  v_mfma_f32_16x16x32_bf16 v[16:19], v[160:163], v[136:139], v[16:19]
  v_mfma_f32_16x16x32_bf16 v[20:23], v[164:167], v[120:123], v[20:23]
  v_mfma_f32_16x16x32_bf16 v[24:27], v[164:167], v[124:127], v[24:27]
  v_mfma_f32_16x16x32_bf16 v[28:31], v[164:167], v[128:131], v[28:31]
  v_mfma_f32_16x16x32_bf16 v[32:35], v[164:167], v[132:135], v[32:35]
  v_mfma_f32_16x16x32_bf16 v[36:39], v[164:167], v[136:139], v[36:39]
  v_mfma_f32_16x16x32_bf16 v[40:43], v[168:171], v[120:123], v[40:43]
  v_mfma_f32_16x16x32_bf16 v[44:47], v[168:171], v[124:127], v[44:47]
  v_mfma_f32_16x16x32_bf16 v[48:51], v[168:171], v[128:131], v[48:51]
  v_mfma_f32_16x16x32_bf16 v[52:55], v[168:171], v[132:135], v[52:55]
  v_mfma_f32_16x16x32_bf16 v[56:59], v[168:171], v[136:139], v[56:59]
  v_mfma_f32_16x16x32_bf16 v[60:63], v[172:175], v[120:123], v[60:63]
  v_mfma_f32_16x16x32_bf16 v[64:67], v[172:175], v[124:127], v[64:67]
  v_mfma_f32_16x16x32_bf16 v[68:71], v[172:175], v[128:131], v[68:71]
  v_mfma_f32_16x16x32_bf16 v[72:75], v[172:175], v[132:135], v[72:75]
  v_mfma_f32_16x16x32_bf16 v[76:79], v[172:175], v[136:139], v[76:79]
  s_add_u32 s18, s16, 6
  s_and_b32 s18, s18, 31
  s_lshl_b32 s18, s18, 10
  buffer_load_dwordx4 v[120:123], v196, s[8:11], s18 offen
  buffer_load_dwordx4 v[124:127], v197, s[8:11], s18 offen
  buffer_load_dwordx4 v[128:131], v198, s[8:11], s18 offen
  buffer_load_dwordx4 v[132:135], v199, s[8:11], s18 offen
  buffer_load_dwordx4 v[136:139], v200, s[8:11], s18 offen
  s_waitcnt vmcnt(27)
  ds_read_b64_tr_b16 v[160:161], v192 offset:16384
  ds_read_b64_tr_b16 v[162:163], v192 offset:18432
  ds_read_b64_tr_b16 v[164:165], v193 offset:16384
  ds_read_b64_tr_b16 v[166:167], v193 offset:18432
  ds_read_b64_tr_b16 v[168:169], v194 offset:16384
  ds_read_b64_tr_b16 v[170:171], v194 offset:18432
  ds_read_b64_tr_b16 v[172:173], v195 offset:16384
  ds_read_b64_tr_b16 v[174:175], v195 offset:18432
  s_waitcnt lgkmcnt(8)
  s_add_u32 s17, s16, 8
  s_and_b32 s17, s17, 31
  s_lshl_b32 s17, s17, 15
  s_add_u32 m0, s43, 0x2000
  s_add_u32 s33, s17, 0x0
  buffer_load_dwordx4 v201, s[4:7], s33 offen lds
  s_add_u32 m0, s43, 0x2400
  s_add_u32 s33, s17, 0x2000
  buffer_load_dwordx4 v201, s[4:7], s33 offen lds
  s_add_u32 m0, s43, 0x2800
  s_add_u32 s33, s17, 0x4000
  buffer_load_dwordx4 v201, s[4:7], s33 offen lds
  s_add_u32 m0, s43, 0x2c00
  s_add_u32 s33, s17, 0x6000
  buffer_load_dwordx4 v201, s[4:7], s33 offen lds
  v_mfma_f32_16x16x32_bf16 v[0:3], v[176:179], v[140:143], v[0:3]
  v_mfma_f32_16x16x32_bf16 v[4:7], v[176:179], v[144:147], v[4:7]
  v_mfma_f32_16x16x32_bf16 v[8:11], v[176:179], v[148:151], v[8:11]
  v_mfma_f32_16x16x32_bf16 v[12:15], v[176:179], v[152:155], v[12:15]
  v_mfma_f32_16x16x32_bf16 v[16:19], v[176:179], v[156:159], v[16:19]
  v_mfma_f32_16x16x32_bf16 v[20:23], v[180:183], v[140:143], v[20:23]
  v_mfma_f32_16x16x32_bf16 v[24:27], v[180:183], v[144:147], v[24:27]
  v_mfma_f32_16x16x32_bf16 v[28:31], v[180:183], v[148:151], v[28:31]
  v_mfma_f32_16x16x32_bf16 v[32:35], v[180:183], v[152:155], v[32:35]
  v_mfma_f32_16x16x32_bf16 v[36:39], v[180:183], v[156:159], v[36:39]
  v_mfma_f32_16x16x32_bf16 v[40:43], v[184:187], v[140:143], v[40:43]
  v_mfma_f32_16x16x32_bf16 v[44:47], v[184:187], v[144:147], v[44:47]
  v_mfma_f32_16x16x32_bf16 v[48:51], v[184:187], v[148:151], v[48:51]
  v_mfma_f32_16x16x32_bf16 v[52:55], v[184:187], v[152:155], v[52:55]
  v_mfma_f32_16x16x32_bf16 v[56:59], v[184:187], v[156:159], v[56:59]
  v_mfma_f32_16x16x32_bf16 v[60:63], v[188:191], v[140:143], v[60:63]
  v_mfma_f32_16x16x32_bf16 v[64:67], v[188:191], v[144:147], v[64:67]
  v_mfma_f32_16x16x32_bf16 v[68:71], v[188:191], v[148:151], v[68:71]
  v_mfma_f32_16x16x32_bf16 v[72:75], v[188:191], v[152:155], v[72:75]
  v_mfma_f32_16x16x32_bf16 v[76:79], v[188:191], v[156:159], v[76:79]
  s_add_u32 s18, s16, 7
  s_and_b32 s18, s18, 31
  s_lshl_b32 s18, s18, 10
  buffer_load_dwordx4 v[140:143], v196, s[8:11], s18 offen
  buffer_load_dwordx4 v[144:147], v197, s[8:11], s18 offen
  buffer_load_dwordx4 v[148:151], v198, s[8:11], s18 offen
  buffer_load_dwordx4 v[152:155], v199, s[8:11], s18 offen
  buffer_load_dwordx4 v[156:159], v200, s[8:11], s18 offen
  s_waitcnt vmcnt(27)
  ds_read_b64_tr_b16 v[176:177], v192 offset:20480
  ds_read_b64_tr_b16 v[178:179], v192 offset:22528
  ds_read_b64_tr_b16 v[180:181], v193 offset:20480
  ds_read_b64_tr_b16 v[182:183], v193 offset:22528
  ds_read_b64_tr_b16 v[184:185], v194 offset:20480
  ds_read_b64_tr_b16 v[186:187], v194 offset:22528
  ds_read_b64_tr_b16 v[188:189], v195 offset:20480
  ds_read_b64_tr_b16 v[190:191], v195 offset:22528
  s_waitcnt lgkmcnt(8)
  s_add_u32 s17, s16, 9
  s_and_b32 s17, s17, 31
  s_lshl_b32 s17, s17, 15
  s_add_u32 m0, s43, 0x3000
  s_add_u32 s33, s17, 0x0
  buffer_load_dwordx4 v201, s[4:7], s33 offen lds
  s_add_u32 m0, s43, 0x3400
  s_add_u32 s33, s17, 0x2000
  buffer_load_dwordx4 v201, s[4:7], s33 offen lds
  s_add_u32 m0, s43, 0x3800
  s_add_u32 s33, s17, 0x4000
  buffer_load_dwordx4 v201, s[4:7], s33 offen lds
  s_add_u32 m0, s43, 0x3c00
  s_add_u32 s33, s17, 0x6000
  buffer_load_dwordx4 v201, s[4:7], s33 offen lds
  v_mfma_f32_16x16x32_bf16 v[0:3], v[160:163], v[80:83], v[0:3]
  v_mfma_f32_16x16x32_bf16 v[4:7], v[160:163], v[84:87], v[4:7]
  v_mfma_f32_16x16x32_bf16 v[8:11], v[160:163], v[88:91], v[8:11]
  v_mfma_f32_16x16x32_bf16 v[12:15], v[160:163], v[92:95], v[12:15]
  v_mfma_f32_16x16x32_bf16 v[16:19], v[160:163], v[96:99], v[16:19]
  v_mfma_f32_16x16x32_bf16 v[20:23], v[164:167], v[80:83], v[20:23]
  v_mfma_f32_16x16x32_bf16 v[24:27], v[164:167], v[84:87], v[24:27]
  v_mfma_f32_16x16x32_bf16 v[28:31], v[164:167], v[88:91], v[28:31]
  v_mfma_f32_16x16x32_bf16 v[32:35], v[164:167], v[92:95], v[32:35]
  v_mfma_f32_16x16x32_bf16 v[36:39], v[164:167], v[96:99], v[36:39]
  v_mfma_f32_16x16x32_bf16 v[40:43], v[168:171], v[80:83], v[40:43]
  v_mfma_f32_16x16x32_bf16 v[44:47], v[168:171], v[84:87], v[44:47]
  v_mfma_f32_16x16x32_bf16 v[48:51], v[168:171], v[88:91], v[48:51]
  v_mfma_f32_16x16x32_bf16 v[52:55], v[168:171], v[92:95], v[52:55]
  v_mfma_f32_16x16x32_bf16 v[56:59], v[168:171], v[96:99], v[56:59]
  v_mfma_f32_16x16x32_bf16 v[60:63], v[172:175], v[80:83], v[60:63]
  v_mfma_f32_16x16x32_bf16 v[64:67], v[172:175], v[84:87], v[64:67]
  v_mfma_f32_16x16x32_bf16 v[68:71], v[172:175], v[88:91], v[68:71]
  v_mfma_f32_16x16x32_bf16 v[72:75], v[172:175], v[92:95], v[72:75]
  v_mfma_f32_16x16x32_bf16 v[76:79], v[172:175], v[96:99], v[76:79]
  s_add_u32 s18, s16, 8
  s_and_b32 s18, s18, 31
  s_lshl_b32 s18, s18, 10
  buffer_load_dwordx4 v[80:83], v196, s[8:11], s18 offen
  buffer_load_dwordx4 v[84:87], v197, s[8:11], s18 offen
  buffer_load_dwordx4 v[88:91], v198, s[8:11], s18 offen
  buffer_load_dwordx4 v[92:95], v199, s[8:11], s18 offen
  buffer_load_dwordx4 v[96:99], v200, s[8:11], s18 offen
  s_waitcnt vmcnt(27)
  ds_read_b64_tr_b16 v[160:161], v192 offset:0
  ds_read_b64_tr_b16 v[162:163], v192 offset:2048
  ds_read_b64_tr_b16 v[164:165], v193 offset:0
  ds_read_b64_tr_b16 v[166:167], v193 offset:2048
  ds_read_b64_tr_b16 v[168:169], v194 offset:0
  ds_read_b64_tr_b16 v[170:171], v194 offset:2048
  ds_read_b64_tr_b16 v[172:173], v195 offset:0
  ds_read_b64_tr_b16 v[174:175], v195 offset:2048
  s_waitcnt lgkmcnt(8)
  s_add_u32 s17, s16, 10
  s_and_b32 s17, s17, 31
  s_lshl_b32 s17, s17, 15
  s_add_u32 m0, s43, 0x4000
  s_add_u32 s33, s17, 0x0
  buffer_load_dwordx4 v201, s[4:7], s33 offen lds
  s_add_u32 m0, s43, 0x4400
  s_add_u32 s33, s17, 0x2000
  buffer_load_dwordx4 v201, s[4:7], s33 offen lds
  s_add_u32 m0, s43, 0x4800
  s_add_u32 s33, s17, 0x4000
  buffer_load_dwordx4 v201, s[4:7], s33 offen lds
  s_add_u32 m0, s43, 0x4c00
  s_add_u32 s33, s17, 0x6000
  buffer_load_dwordx4 v201, s[4:7], s33 offen lds
  v_mfma_f32_16x16x32_bf16 v[0:3], v[176:179], v[100:103], v[0:3]
  v_mfma_f32_16x16x32_bf16 v[4:7], v[176:179], v[104:107], v[4:7]
  v_mfma_f32_16x16x32_bf16 v[8:11], v[176:179], v[108:111], v[8:11]
  v_mfma_f32_16x16x32_bf16 v[12:15], v[176:179], v[112:115], v[12:15]
  v_mfma_f32_16x16x32_bf16 v[16:19], v[176:179], v[116:119], v[16:19]
  v_mfma_f32_16x16x32_bf16 v[20:23], v[180:183], v[100:103], v[20:23]
  v_mfma_f32_16x16x32_bf16 v[24:27], v[180:183], v[104:107], v[24:27]
  v_mfma_f32_16x16x32_bf16 v[28:31], v[180:183], v[108:111], v[28:31]
  v_mfma_f32_16x16x32_bf16 v[32:35], v[180:183], v[112:115], v[32:35]
  v_mfma_f32_16x16x32_bf16 v[36:39], v[180:183], v[116:119], v[36:39]
  v_mfma_f32_16x16x32_bf16 v[40:43], v[184:187], v[100:103], v[40:43]
  v_mfma_f32_16x16x32_bf16 v[44:47], v[184:187], v[104:107], v[44:47]
  v_mfma_f32_16x16x32_bf16 v[48:51], v[184:187], v[108:111], v[48:51]
  v_mfma_f32_16x16x32_bf16 v[52:55], v[184:187], v[112:115], v[52:55]
  v_mfma_f32_16x16x32_bf16 v[56:59], v[184:187], v[116:119], v[56:59]
  v_mfma_f32_16x16x32_bf16 v[60:63], v[188:191], v[100:103], v[60:63]
  v_mfma_f32_16x16x32_bf16 v[64:67], v[188:191], v[104:107], v[64:67]
  v_mfma_f32_16x16x32_bf16 v[68:71], v[188:191], v[108:111], v[68:71]
  v_mfma_f32_16x16x32_bf16 v[72:75], v[188:191], v[112:115], v[72:75]
  v_mfma_f32_16x16x32_bf16 v[76:79], v[188:191], v[116:119], v[76:79]
  s_add_u32 s18, s16, 9
  s_and_b32 s18, s18, 31
  s_lshl_b32 s18, s18, 10
  buffer_load_dwordx4 v[100:103], v196, s[8:11], s18 offen
  buffer_load_dwordx4 v[104:107], v197, s[8:11], s18 offen
  buffer_load_dwordx4 v[108:111], v198, s[8:11], s18 offen
  buffer_load_dwordx4 v[112:115], v199, s[8:11], s18 offen
  buffer_load_dwordx4 v[116:119], v200, s[8:11], s18 offen
  s_waitcnt vmcnt(27)
  ds_read_b64_tr_b16 v[176:177], v192 offset:4096
  ds_read_b64_tr_b16 v[178:179], v192 offset:6144
  ds_read_b64_tr_b16 v[180:181], v193 offset:4096
  ds_read_b64_tr_b16 v[182:183], v193 offset:6144
  ds_read_b64_tr_b16 v[184:185], v194 offset:4096
  ds_read_b64_tr_b16 v[186:187], v194 offset:6144
  ds_read_b64_tr_b16 v[188:189], v195 offset:4096
  ds_read_b64_tr_b16 v[190:191], v195 offset:6144
  s_waitcnt lgkmcnt(8)
  s_add_u32 s17, s16, 11
  s_and_b32 s17, s17, 31
  s_lshl_b32 s17, s17, 15
  s_add_u32 m0, s43, 0x5000
  s_add_u32 s33, s17, 0x0
  buffer_load_dwordx4 v201, s[4:7], s33 offen lds
  s_add_u32 m0, s43, 0x5400
  s_add_u32 s33, s17, 0x2000
  buffer_load_dwordx4 v201, s[4:7], s33 offen lds
  s_add_u32 m0, s43, 0x5800
  s_add_u32 s33, s17, 0x4000
  buffer_load_dwordx4 v201, s[4:7], s33 offen lds
  s_add_u32 m0, s43, 0x5c00
  s_add_u32 s33, s17, 0x6000
  buffer_load_dwordx4 v201, s[4:7], s33 offen lds
  v_mfma_f32_16x16x32_bf16 v[0:3], v[160:163], v[120:123], v[0:3]
  v_mfma_f32_16x16x32_bf16 v[4:7], v[160:163], v[124:127], v[4:7]
  v_mfma_f32_16x16x32_bf16 v[8:11], v[160:163], v[128:131], v[8:11]
  v_mfma_f32_16x16x32_bf16 v[12:15], v[160:163], v[132:135], v[12:15]
  v_mfma_f32_16x16x32_bf16 v[16:19], v[160:163], v[136:139], v[16:19]
  v_mfma_f32_16x16x32_bf16 v[20:23], v[164:167], v[120:123], v[20:23]
  v_mfma_f32_16x16x32_bf16 v[24:27], v[164:167], v[124:127], v[24:27]
  v_mfma_f32_16x16x32_bf16 v[28:31], v[164:167], v[128:131], v[28:31]
  v_mfma_f32_16x16x32_bf16 v[32:35], v[164:167], v[132:135], v[32:35]
  v_mfma_f32_16x16x32_bf16 v[36:39], v[164:167], v[136:139], v[36:39]
  v_mfma_f32_16x16x32_bf16 v[40:43], v[168:171], v[120:123], v[40:43]
  v_mfma_f32_16x16x32_bf16 v[44:47], v[168:171], v[124:127], v[44:47]
  v_mfma_f32_16x16x32_bf16 v[48:51], v[168:171], v[128:131], v[48:51]
  v_mfma_f32_16x16x32_bf16 v[52:55], v[168:171], v[132:135], v[52:55]
  v_mfma_f32_16x16x32_bf16 v[56:59], v[168:171], v[136:139], v[56:59]
  v_mfma_f32_16x16x32_bf16 v[60:63], v[172:175], v[120:123], v[60:63]
  v_mfma_f32_16x16x32_bf16 v[64:67], v[172:175], v[124:127], v[64:67]
  v_mfma_f32_16x16x32_bf16 v[68:71], v[172:175], v[128:131], v[68:71]
  v_mfma_f32_16x16x32_bf16 v[72:75], v[172:175], v[132:135], v[72:75]
  v_mfma_f32_16x16x32_bf16 v[76:79], v[172:175], v[136:139], v[76:79]
  s_add_u32 s18, s16, 10
  s_and_b32 s18, s18, 31
  s_lshl_b32 s18, s18, 10
  buffer_load_dwordx4 v[120:123], v196, s[8:11], s18 offen
  buffer_load_dwordx4 v[124:127], v197, s[8:11], s18 offen
  buffer_load_dwordx4 v[128:131], v198, s[8:11], s18 offen
  buffer_load_dwordx4 v[132:135], v199, s[8:11], s18 offen
  buffer_load_dwordx4 v[136:139], v200, s[8:11], s18 offen
  s_waitcnt vmcnt(27)
  ds_read_b64_tr_b16 v[160:161], v192 offset:8192
  ds_read_b64_tr_b16 v[162:163], v192 offset:10240
  ds_read_b64_tr_b16 v[164:165], v193 offset:8192
  ds_read_b64_tr_b16 v[166:167], v193 offset:10240
  ds_read_b64_tr_b16 v[168:169], v194 offset:8192
  ds_read_b64_tr_b16 v[170:171], v194 offset:10240
  ds_read_b64_tr_b16 v[172:173], v195 offset:8192
  ds_read_b64_tr_b16 v[174:175], v195 offset:10240
  s_waitcnt lgkmcnt(8)
  s_add_u32 s17, s16, 12
  s_and_b32 s17, s17, 31
  s_lshl_b32 s17, s17, 15
  s_add_u32 m0, s43, 0x0
  s_add_u32 s33, s17, 0x0
  buffer_load_dwordx4 v201, s[4:7], s33 offen lds
  s_add_u32 m0, s43, 0x400
  s_add_u32 s33, s17, 0x2000
  buffer_load_dwordx4 v201, s[4:7], s33 offen lds
  s_add_u32 m0, s43, 0x800
  s_add_u32 s33, s17, 0x4000
  buffer_load_dwordx4 v201, s[4:7], s33 offen lds
  s_add_u32 m0, s43, 0xc00
  s_add_u32 s33, s17, 0x6000
  buffer_load_dwordx4 v201, s[4:7], s33 offen lds
  v_mfma_f32_16x16x32_bf16 v[0:3], v[176:179], v[140:143], v[0:3]
  v_mfma_f32_16x16x32_bf16 v[4:7], v[176:179], v[144:147], v[4:7]
  v_mfma_f32_16x16x32_bf16 v[8:11], v[176:179], v[148:151], v[8:11]
  v_mfma_f32_16x16x32_bf16 v[12:15], v[176:179], v[152:155], v[12:15]
  v_mfma_f32_16x16x32_bf16 v[16:19], v[176:179], v[156:159], v[16:19]
  v_mfma_f32_16x16x32_bf16 v[20:23], v[180:183], v[140:143], v[20:23]
  v_mfma_f32_16x16x32_bf16 v[24:27], v[180:183], v[144:147], v[24:27]
  v_mfma_f32_16x16x32_bf16 v[28:31], v[180:183], v[148:151], v[28:31]
  v_mfma_f32_16x16x32_bf16 v[32:35], v[180:183], v[152:155], v[32:35]
  v_mfma_f32_16x16x32_bf16 v[36:39], v[180:183], v[156:159], v[36:39]
  v_mfma_f32_16x16x32_bf16 v[40:43], v[184:187], v[140:143], v[40:43]
  v_mfma_f32_16x16x32_bf16 v[44:47], v[184:187], v[144:147], v[44:47]
  v_mfma_f32_16x16x32_bf16 v[48:51], v[184:187], v[148:151], v[48:51]
  v_mfma_f32_16x16x32_bf16 v[52:55], v[184:187], v[152:155], v[52:55]
  v_mfma_f32_16x16x32_bf16 v[56:59], v[184:187], v[156:159], v[56:59]
  v_mfma_f32_16x16x32_bf16 v[60:63], v[188:191], v[140:143], v[60:63]
  v_mfma_f32_16x16x32_bf16 v[64:67], v[188:191], v[144:147], v[64:67]
  v_mfma_f32_16x16x32_bf16 v[68:71], v[188:191], v[148:151], v[68:71]
  v_mfma_f32_16x16x32_bf16 v[72:75], v[188:191], v[152:155], v[72:75]
  v_mfma_f32_16x16x32_bf16 v[76:79], v[188:191], v[156:159], v[76:79]
  s_add_u32 s18, s16, 11
  s_and_b32 s18, s18, 31
  s_lshl_b32 s18, s18, 10
  buffer_load_dwordx4 v[140:143], v196, s[8:11], s18 offen
  buffer_load_dwordx4 v[144:147], v197, s[8:11], s18 offen
  buffer_load_dwordx4 v[148:151], v198, s[8:11], s18 offen
  buffer_load_dwordx4 v[152:155], v199, s[8:11], s18 offen
  buffer_load_dwordx4 v[156:159], v200, s[8:11], s18 offen
  s_waitcnt vmcnt(27)
  ds_read_b64_tr_b16 v[176:177], v192 offset:12288
  ds_read_b64_tr_b16 v[178:179], v192 offset:14336
  ds_read_b64_tr_b16 v[180:181], v193 offset:12288
  ds_read_b64_tr_b16 v[182:183], v193 offset:14336
  ds_read_b64_tr_b16 v[184:185], v194 offset:12288
  ds_read_b64_tr_b16 v[186:187], v194 offset:14336
  ds_read_b64_tr_b16 v[188:189], v195 offset:12288
  ds_read_b64_tr_b16 v[190:191], v195 offset:14336
  s_waitcnt lgkmcnt(8)
  s_add_u32 s17, s16, 13
  s_and_b32 s17, s17, 31
  s_lshl_b32 s17, s17, 15
  s_add_u32 m0, s43, 0x1000
  s_add_u32 s33, s17, 0x0
  buffer_load_dwordx4 v201, s[4:7], s33 offen lds
  s_add_u32 m0, s43, 0x1400
  s_add_u32 s33, s17, 0x2000
  buffer_load_dwordx4 v201, s[4:7], s33 offen lds
  s_add_u32 m0, s43, 0x1800
  s_add_u32 s33, s17, 0x4000
  buffer_load_dwordx4 v201, s[4:7], s33 offen lds
  s_add_u32 m0, s43, 0x1c00
  s_add_u32 s33, s17, 0x6000
  buffer_load_dwordx4 v201, s[4:7], s33 offen lds
  v_mfma_f32_16x16x32_bf16 v[0:3], v[160:163], v[80:83], v[0:3]
  v_mfma_f32_16x16x32_bf16 v[4:7], v[160:163], v[84:87], v[4:7]
  v_mfma_f32_16x16x32_bf16 v[8:11], v[160:163], v[88:91], v[8:11]
  v_mfma_f32_16x16x32_bf16 v[12:15], v[160:163], v[92:95], v[12:15]
  v_mfma_f32_16x16x32_bf16 v[16:19], v[160:163], v[96:99], v[16:19]
  v_mfma_f32_16x16x32_bf16 v[20:23], v[164:167], v[80:83], v[20:23]
  v_mfma_f32_16x16x32_bf16 v[24:27], v[164:167], v[84:87], v[24:27]
  v_mfma_f32_16x16x32_bf16 v[28:31], v[164:167], v[88:91], v[28:31]
  v_mfma_f32_16x16x32_bf16 v[32:35], v[164:167], v[92:95], v[32:35]
  v_mfma_f32_16x16x32_bf16 v[36:39], v[164:167], v[96:99], v[36:39]
  v_mfma_f32_16x16x32_bf16 v[40:43], v[168:171], v[80:83], v[40:43]
  v_mfma_f32_16x16x32_bf16 v[44:47], v[168:171], v[84:87], v[44:47]
  v_mfma_f32_16x16x32_bf16 v[48:51], v[168:171], v[88:91], v[48:51]
  v_mfma_f32_16x16x32_bf16 v[52:55], v[168:171], v[92:95], v[52:55]
  v_mfma_f32_16x16x32_bf16 v[56:59], v[168:171], v[96:99], v[56:59]
  v_mfma_f32_16x16x32_bf16 v[60:63], v[172:175], v[80:83], v[60:63]
  v_mfma_f32_16x16x32_bf16 v[64:67], v[172:175], v[84:87], v[64:67]
  v_mfma_f32_16x16x32_bf16 v[68:71], v[172:175], v[88:91], v[68:71]
  v_mfma_f32_16x16x32_bf16 v[72:75], v[172:175], v[92:95], v[72:75]
  v_mfma_f32_16x16x32_bf16 v[76:79], v[172:175], v[96:99], v[76:79]
  s_add_u32 s18, s16, 12
  s_and_b32 s18, s18, 31
  s_lshl_b32 s18, s18, 10
  buffer_load_dwordx4 v[80:83], v196, s[8:11], s18 offen
  buffer_load_dwordx4 v[84:87], v197, s[8:11], s18 offen
  buffer_load_dwordx4 v[88:91], v198, s[8:11], s18 offen
  buffer_load_dwordx4 v[92:95], v199, s[8:11], s18 offen
  buffer_load_dwordx4 v[96:99], v200, s[8:11], s18 offen
  s_waitcnt vmcnt(27)
  ds_read_b64_tr_b16 v[160:161], v192 offset:16384
  ds_read_b64_tr_b16 v[162:163], v192 offset:18432
  ds_read_b64_tr_b16 v[164:165], v193 offset:16384
  ds_read_b64_tr_b16 v[166:167], v193 offset:18432
  ds_read_b64_tr_b16 v[168:169], v194 offset:16384
  ds_read_b64_tr_b16 v[170:171], v194 offset:18432
  ds_read_b64_tr_b16 v[172:173], v195 offset:16384
  ds_read_b64_tr_b16 v[174:175], v195 offset:18432
  s_waitcnt lgkmcnt(8)
  s_add_u32 s17, s16, 14
  s_and_b32 s17, s17, 31
  s_lshl_b32 s17, s17, 15
  s_add_u32 m0, s43, 0x2000
  s_add_u32 s33, s17, 0x0
  buffer_load_dwordx4 v201, s[4:7], s33 offen lds
  s_add_u32 m0, s43, 0x2400
  s_add_u32 s33, s17, 0x2000
  buffer_load_dwordx4 v201, s[4:7], s33 offen lds
  s_add_u32 m0, s43, 0x2800
  s_add_u32 s33, s17, 0x4000
  buffer_load_dwordx4 v201, s[4:7], s33 offen lds
  s_add_u32 m0, s43, 0x2c00
  s_add_u32 s33, s17, 0x6000
  buffer_load_dwordx4 v201, s[4:7], s33 offen lds
  v_mfma_f32_16x16x32_bf16 v[0:3], v[176:179], v[100:103], v[0:3]
  v_mfma_f32_16x16x32_bf16 v[4:7], v[176:179], v[104:107], v[4:7]
  v_mfma_f32_16x16x32_bf16 v[8:11], v[176:179], v[108:111], v[8:11]
  v_mfma_f32_16x16x32_bf16 v[12:15], v[176:179], v[112:115], v[12:15]
  v_mfma_f32_16x16x32_bf16 v[16:19], v[176:179], v[116:119], v[16:19]
  v_mfma_f32_16x16x32_bf16 v[20:23], v[180:183], v[100:103], v[20:23]
  v_mfma_f32_16x16x32_bf16 v[24:27], v[180:183], v[104:107], v[24:27]
  v_mfma_f32_16x16x32_bf16 v[28:31], v[180:183], v[108:111], v[28:31]
  v_mfma_f32_16x16x32_bf16 v[32:35], v[180:183], v[112:115], v[32:35]
  v_mfma_f32_16x16x32_bf16 v[36:39], v[180:183], v[116:119], v[36:39]
  v_mfma_f32_16x16x32_bf16 v[40:43], v[184:187], v[100:103], v[40:43]
  v_mfma_f32_16x16x32_bf16 v[44:47], v[184:187], v[104:107], v[44:47]
  v_mfma_f32_16x16x32_bf16 v[48:51], v[184:187], v[108:111], v[48:51]
  v_mfma_f32_16x16x32_bf16 v[52:55], v[184:187], v[112:115], v[52:55]
  v_mfma_f32_16x16x32_bf16 v[56:59], v[184:187], v[116:119], v[56:59]
  v_mfma_f32_16x16x32_bf16 v[60:63], v[188:191], v[100:103], v[60:63]
  v_mfma_f32_16x16x32_bf16 v[64:67], v[188:191], v[104:107], v[64:67]
  v_mfma_f32_16x16x32_bf16 v[68:71], v[188:191], v[108:111], v[68:71]
  v_mfma_f32_16x16x32_bf16 v[72:75], v[188:191], v[112:115], v[72:75]
  v_mfma_f32_16x16x32_bf16 v[76:79], v[188:191], v[116:119], v[76:79]
  s_add_u32 s18, s16, 13
  s_and_b32 s18, s18, 31
  s_lshl_b32 s18, s18, 10
  buffer_load_dwordx4 v[100:103], v196, s[8:11], s18 offen
  buffer_load_dwordx4 v[104:107], v197, s[8:11], s18 offen
  buffer_load_dwordx4 v[108:111], v198, s[8:11], s18 offen
  buffer_load_dwordx4 v[112:115], v199, s[8:11], s18 offen
  buffer_load_dwordx4 v[116:119], v200, s[8:11], s18 offen
  s_waitcnt vmcnt(27)
  ds_read_b64_tr_b16 v[176:177], v192 offset:20480
  ds_read_b64_tr_b16 v[178:179], v192 offset:22528
  ds_read_b64_tr_b16 v[180:181], v193 offset:20480
  ds_read_b64_tr_b16 v[182:183], v193 offset:22528
  ds_read_b64_tr_b16 v[184:185], v194 offset:20480
  ds_read_b64_tr_b16 v[186:187], v194 offset:22528
  ds_read_b64_tr_b16 v[188:189], v195 offset:20480
  ds_read_b64_tr_b16 v[190:191], v195 offset:22528
  s_waitcnt lgkmcnt(8)
  s_add_u32 s17, s16, 15
  s_and_b32 s17, s17, 31
  s_lshl_b32 s17, s17, 15
  s_add_u32 m0, s43, 0x3000
  s_add_u32 s33, s17, 0x0
  buffer_load_dwordx4 v201, s[4:7], s33 offen lds
  s_add_u32 m0, s43, 0x3400
  s_add_u32 s33, s17, 0x2000
  buffer_load_dwordx4 v201, s[4:7], s33 offen lds
  s_add_u32 m0, s43, 0x3800
  s_add_u32 s33, s17, 0x4000
  buffer_load_dwordx4 v201, s[4:7], s33 offen lds
  s_add_u32 m0, s43, 0x3c00
  s_add_u32 s33, s17, 0x6000
  buffer_load_dwordx4 v201, s[4:7], s33 offen lds
  v_mfma_f32_16x16x32_bf16 v[0:3], v[160:163], v[120:123], v[0:3]
  v_mfma_f32_16x16x32_bf16 v[4:7], v[160:163], v[124:127], v[4:7]
  v_mfma_f32_16x16x32_bf16 v[8:11], v[160:163], v[128:131], v[8:11]
  v_mfma_f32_16x16x32_bf16 v[12:15], v[160:163], v[132:135], v[12:15]
  v_mfma_f32_16x16x32_bf16 v[16:19], v[160:163], v[136:139], v[16:19]
  v_mfma_f32_16x16x32_bf16 v[20:23], v[164:167], v[120:123], v[20:23]
  v_mfma_f32_16x16x32_bf16 v[24:27], v[164:167], v[124:127], v[24:27]
  v_mfma_f32_16x16x32_bf16 v[28:31], v[164:167], v[128:131], v[28:31]
  v_mfma_f32_16x16x32_bf16 v[32:35], v[164:167], v[132:135], v[32:35]
  v_mfma_f32_16x16x32_bf16 v[36:39], v[164:167], v[136:139], v[36:39]
  v_mfma_f32_16x16x32_bf16 v[40:43], v[168:171], v[120:123], v[40:43]
  v_mfma_f32_16x16x32_bf16 v[44:47], v[168:171], v[124:127], v[44:47]
  v_mfma_f32_16x16x32_bf16 v[48:51], v[168:171], v[128:131], v[48:51]
  v_mfma_f32_16x16x32_bf16 v[52:55], v[168:171], v[132:135], v[52:55]
  v_mfma_f32_16x16x32_bf16 v[56:59], v[168:171], v[136:139], v[56:59]
  v_mfma_f32_16x16x32_bf16 v[60:63], v[172:175], v[120:123], v[60:63]
  v_mfma_f32_16x16x32_bf16 v[64:67], v[172:175], v[124:127], v[64:67]
  v_mfma_f32_16x16x32_bf16 v[68:71], v[172:175], v[128:131], v[68:71]
  v_mfma_f32_16x16x32_bf16 v[72:75], v[172:175], v[132:135], v[72:75]
  v_mfma_f32_16x16x32_bf16 v[76:79], v[172:175], v[136:139], v[76:79]
  s_add_u32 s18, s16, 14
  s_and_b32 s18, s18, 31
  s_lshl_b32 s18, s18, 10
  buffer_load_dwordx4 v[120:123], v196, s[8:11], s18 offen
  buffer_load_dwordx4 v[124:127], v197, s[8:11], s18 offen
  buffer_load_dwordx4 v[128:131], v198, s[8:11], s18 offen
  buffer_load_dwordx4 v[132:135], v199, s[8:11], s18 offen
  buffer_load_dwordx4 v[136:139], v200, s[8:11], s18 offen
  s_waitcnt vmcnt(27)
  ds_read_b64_tr_b16 v[160:161], v192 offset:0
  ds_read_b64_tr_b16 v[162:163], v192 offset:2048
  ds_read_b64_tr_b16 v[164:165], v193 offset:0
  ds_read_b64_tr_b16 v[166:167], v193 offset:2048
  ds_read_b64_tr_b16 v[168:169], v194 offset:0
  ds_read_b64_tr_b16 v[170:171], v194 offset:2048
  ds_read_b64_tr_b16 v[172:173], v195 offset:0
  ds_read_b64_tr_b16 v[174:175], v195 offset:2048
  s_waitcnt lgkmcnt(8)
  s_add_u32 s17, s16, 16
  s_and_b32 s17, s17, 31
  s_lshl_b32 s17, s17, 15
  s_add_u32 m0, s43, 0x4000
  s_add_u32 s33, s17, 0x0
  buffer_load_dwordx4 v201, s[4:7], s33 offen lds
  s_add_u32 m0, s43, 0x4400
  s_add_u32 s33, s17, 0x2000
  buffer_load_dwordx4 v201, s[4:7], s33 offen lds
  s_add_u32 m0, s43, 0x4800
  s_add_u32 s33, s17, 0x4000
  buffer_load_dwordx4 v201, s[4:7], s33 offen lds
  s_add_u32 m0, s43, 0x4c00
  s_add_u32 s33, s17, 0x6000
  buffer_load_dwordx4 v201, s[4:7], s33 offen lds
  v_mfma_f32_16x16x32_bf16 v[0:3], v[176:179], v[140:143], v[0:3]
  v_mfma_f32_16x16x32_bf16 v[4:7], v[176:179], v[144:147], v[4:7]
  v_mfma_f32_16x16x32_bf16 v[8:11], v[176:179], v[148:151], v[8:11]
  v_mfma_f32_16x16x32_bf16 v[12:15], v[176:179], v[152:155], v[12:15]
  v_mfma_f32_16x16x32_bf16 v[16:19], v[176:179], v[156:159], v[16:19]
  v_mfma_f32_16x16x32_bf16 v[20:23], v[180:183], v[140:143], v[20:23]
  v_mfma_f32_16x16x32_bf16 v[24:27], v[180:183], v[144:147], v[24:27]
  v_mfma_f32_16x16x32_bf16 v[28:31], v[180:183], v[148:151], v[28:31]
  v_mfma_f32_16x16x32_bf16 v[32:35], v[180:183], v[152:155], v[32:35]
  v_mfma_f32_16x16x32_bf16 v[36:39], v[180:183], v[156:159], v[36:39]
  v_mfma_f32_16x16x32_bf16 v[40:43], v[184:187], v[140:143], v[40:43]
  v_mfma_f32_16x16x32_bf16 v[44:47], v[184:187], v[144:147], v[44:47]
  v_mfma_f32_16x16x32_bf16 v[48:51], v[184:187], v[148:151], v[48:51]
  v_mfma_f32_16x16x32_bf16 v[52:55], v[184:187], v[152:155], v[52:55]
  v_mfma_f32_16x16x32_bf16 v[56:59], v[184:187], v[156:159], v[56:59]
  v_mfma_f32_16x16x32_bf16 v[60:63], v[188:191], v[140:143], v[60:63]
  v_mfma_f32_16x16x32_bf16 v[64:67], v[188:191], v[144:147], v[64:67]
  v_mfma_f32_16x16x32_bf16 v[68:71], v[188:191], v[148:151], v[68:71]
  v_mfma_f32_16x16x32_bf16 v[72:75], v[188:191], v[152:155], v[72:75]
  v_mfma_f32_16x16x32_bf16 v[76:79], v[188:191], v[156:159], v[76:79]
  s_add_u32 s18, s16, 15
  s_and_b32 s18, s18, 31
  s_lshl_b32 s18, s18, 10
  buffer_load_dwordx4 v[140:143], v196, s[8:11], s18 offen
  buffer_load_dwordx4 v[144:147], v197, s[8:11], s18 offen
  buffer_load_dwordx4 v[148:151], v198, s[8:11], s18 offen
  buffer_load_dwordx4 v[152:155], v199, s[8:11], s18 offen
  buffer_load_dwordx4 v[156:159], v200, s[8:11], s18 offen
  s_waitcnt vmcnt(27)
  ds_read_b64_tr_b16 v[176:177], v192 offset:4096
  ds_read_b64_tr_b16 v[178:179], v192 offset:6144
  ds_read_b64_tr_b16 v[180:181], v193 offset:4096
  ds_read_b64_tr_b16 v[182:183], v193 offset:6144
  ds_read_b64_tr_b16 v[184:185], v194 offset:4096
  ds_read_b64_tr_b16 v[186:187], v194 offset:6144
  ds_read_b64_tr_b16 v[188:189], v195 offset:4096
  ds_read_b64_tr_b16 v[190:191], v195 offset:6144
  s_waitcnt lgkmcnt(8)
  s_add_u32 s17, s16, 17
  s_and_b32 s17, s17, 31
  s_lshl_b32 s17, s17, 15
  s_add_u32 m0, s43, 0x5000
  s_add_u32 s33, s17, 0x0
  buffer_load_dwordx4 v201, s[4:7], s33 offen lds
  s_add_u32 m0, s43, 0x5400
  s_add_u32 s33, s17, 0x2000
  buffer_load_dwordx4 v201, s[4:7], s33 offen lds
  s_add_u32 m0, s43, 0x5800
  s_add_u32 s33, s17, 0x4000
  buffer_load_dwordx4 v201, s[4:7], s33 offen lds
  s_add_u32 m0, s43, 0x5c00
  s_add_u32 s33, s17, 0x6000
  buffer_load_dwordx4 v201, s[4:7], s33 offen lds
  v_mfma_f32_16x16x32_bf16 v[0:3], v[160:163], v[80:83], v[0:3]
  v_mfma_f32_16x16x32_bf16 v[4:7], v[160:163], v[84:87], v[4:7]
  v_mfma_f32_16x16x32_bf16 v[8:11], v[160:163], v[88:91], v[8:11]
  v_mfma_f32_16x16x32_bf16 v[12:15], v[160:163], v[92:95], v[12:15]
  v_mfma_f32_16x16x32_bf16 v[16:19], v[160:163], v[96:99], v[16:19]
  v_mfma_f32_16x16x32_bf16 v[20:23], v[164:167], v[80:83], v[20:23]
  v_mfma_f32_16x16x32_bf16 v[24:27], v[164:167], v[84:87], v[24:27]
  v_mfma_f32_16x16x32_bf16 v[28:31], v[164:167], v[88:91], v[28:31]
  v_mfma_f32_16x16x32_bf16 v[32:35], v[164:167], v[92:95], v[32:35]
  v_mfma_f32_16x16x32_bf16 v[36:39], v[164:167], v[96:99], v[36:39]
  v_mfma_f32_16x16x32_bf16 v[40:43], v[168:171], v[80:83], v[40:43]
  v_mfma_f32_16x16x32_bf16 v[44:47], v[168:171], v[84:87], v[44:47]
  v_mfma_f32_16x16x32_bf16 v[48:51], v[168:171], v[88:91], v[48:51]
  v_mfma_f32_16x16x32_bf16 v[52:55], v[168:171], v[92:95], v[52:55]
  v_mfma_f32_16x16x32_bf16 v[56:59], v[168:171], v[96:99], v[56:59]
  v_mfma_f32_16x16x32_bf16 v[60:63], v[172:175], v[80:83], v[60:63]
  v_mfma_f32_16x16x32_bf16 v[64:67], v[172:175], v[84:87], v[64:67]
  v_mfma_f32_16x16x32_bf16 v[68:71], v[172:175], v[88:91], v[68:71]
  v_mfma_f32_16x16x32_bf16 v[72:75], v[172:175], v[92:95], v[72:75]
  v_mfma_f32_16x16x32_bf16 v[76:79], v[172:175], v[96:99], v[76:79]
  s_add_u32 s18, s16, 16
  s_and_b32 s18, s18, 31
  s_lshl_b32 s18, s18, 10
  buffer_load_dwordx4 v[80:83], v196, s[8:11], s18 offen
  buffer_load_dwordx4 v[84:87], v197, s[8:11], s18 offen
  buffer_load_dwordx4 v[88:91], v198, s[8:11], s18 offen
  buffer_load_dwordx4 v[92:95], v199, s[8:11], s18 offen
  buffer_load_dwordx4 v[96:99], v200, s[8:11], s18 offen
  s_waitcnt vmcnt(27)
  ds_read_b64_tr_b16 v[160:161], v192 offset:8192
  ds_read_b64_tr_b16 v[162:163], v192 offset:10240
  ds_read_b64_tr_b16 v[164:165], v193 offset:8192
  ds_read_b64_tr_b16 v[166:167], v193 offset:10240
  ds_read_b64_tr_b16 v[168:169], v194 offset:8192
  ds_read_b64_tr_b16 v[170:171], v194 offset:10240
  ds_read_b64_tr_b16 v[172:173], v195 offset:8192
  ds_read_b64_tr_b16 v[174:175], v195 offset:10240
  s_waitcnt lgkmcnt(8)
  s_add_u32 s17, s16, 18
  s_and_b32 s17, s17, 31
  s_lshl_b32 s17, s17, 15
  s_add_u32 m0, s43, 0x0
  s_add_u32 s33, s17, 0x0
  buffer_load_dwordx4 v201, s[4:7], s33 offen lds
  s_add_u32 m0, s43, 0x400
  s_add_u32 s33, s17, 0x2000
  buffer_load_dwordx4 v201, s[4:7], s33 offen lds
  s_add_u32 m0, s43, 0x800
  s_add_u32 s33, s17, 0x4000
  buffer_load_dwordx4 v201, s[4:7], s33 offen lds
  s_add_u32 m0, s43, 0xc00
  s_add_u32 s33, s17, 0x6000
  buffer_load_dwordx4 v201, s[4:7], s33 offen lds
  v_mfma_f32_16x16x32_bf16 v[0:3], v[176:179], v[100:103], v[0:3]
  v_mfma_f32_16x16x32_bf16 v[4:7], v[176:179], v[104:107], v[4:7]
  v_mfma_f32_16x16x32_bf16 v[8:11], v[176:179], v[108:111], v[8:11]
  v_mfma_f32_16x16x32_bf16 v[12:15], v[176:179], v[112:115], v[12:15]
  v_mfma_f32_16x16x32_bf16 v[16:19], v[176:179], v[116:119], v[16:19]
  v_mfma_f32_16x16x32_bf16 v[20:23], v[180:183], v[100:103], v[20:23]
  v_mfma_f32_16x16x32_bf16 v[24:27], v[180:183], v[104:107], v[24:27]
  v_mfma_f32_16x16x32_bf16 v[28:31], v[180:183], v[108:111], v[28:31]
  v_mfma_f32_16x16x32_bf16 v[32:35], v[180:183], v[112:115], v[32:35]
  v_mfma_f32_16x16x32_bf16 v[36:39], v[180:183], v[116:119], v[36:39]
  v_mfma_f32_16x16x32_bf16 v[40:43], v[184:187], v[100:103], v[40:43]
  v_mfma_f32_16x16x32_bf16 v[44:47], v[184:187], v[104:107], v[44:47]
  v_mfma_f32_16x16x32_bf16 v[48:51], v[184:187], v[108:111], v[48:51]
  v_mfma_f32_16x16x32_bf16 v[52:55], v[184:187], v[112:115], v[52:55]
  v_mfma_f32_16x16x32_bf16 v[56:59], v[184:187], v[116:119], v[56:59]
  v_mfma_f32_16x16x32_bf16 v[60:63], v[188:191], v[100:103], v[60:63]
  v_mfma_f32_16x16x32_bf16 v[64:67], v[188:191], v[104:107], v[64:67]
  v_mfma_f32_16x16x32_bf16 v[68:71], v[188:191], v[108:111], v[68:71]
  v_mfma_f32_16x16x32_bf16 v[72:75], v[188:191], v[112:115], v[72:75]
  v_mfma_f32_16x16x32_bf16 v[76:79], v[188:191], v[116:119], v[76:79]
  s_add_u32 s18, s16, 17
  s_and_b32 s18, s18, 31
  s_lshl_b32 s18, s18, 10
  buffer_load_dwordx4 v[100:103], v196, s[8:11], s18 offen
  buffer_load_dwordx4 v[104:107], v197, s[8:11], s18 offen
  buffer_load_dwordx4 v[108:111], v198, s[8:11], s18 offen
  buffer_load_dwordx4 v[112:115], v199, s[8:11], s18 offen
  buffer_load_dwordx4 v[116:119], v200, s[8:11], s18 offen
  s_waitcnt vmcnt(27)
  ds_read_b64_tr_b16 v[176:177], v192 offset:12288
  ds_read_b64_tr_b16 v[178:179], v192 offset:14336
  ds_read_b64_tr_b16 v[180:181], v193 offset:12288
  ds_read_b64_tr_b16 v[182:183], v193 offset:14336
  ds_read_b64_tr_b16 v[184:185], v194 offset:12288
  ds_read_b64_tr_b16 v[186:187], v194 offset:14336
  ds_read_b64_tr_b16 v[188:189], v195 offset:12288
  ds_read_b64_tr_b16 v[190:191], v195 offset:14336
  s_waitcnt lgkmcnt(8)
  s_add_u32 s17, s16, 19
  s_and_b32 s17, s17, 31
  s_lshl_b32 s17, s17, 15
  s_add_u32 m0, s43, 0x1000
  s_add_u32 s33, s17, 0x0
  buffer_load_dwordx4 v201, s[4:7], s33 offen lds
  s_add_u32 m0, s43, 0x1400
  s_add_u32 s33, s17, 0x2000
  buffer_load_dwordx4 v201, s[4:7], s33 offen lds
  s_add_u32 m0, s43, 0x1800
  s_add_u32 s33, s17, 0x4000
  buffer_load_dwordx4 v201, s[4:7], s33 offen lds
  s_add_u32 m0, s43, 0x1c00
  s_add_u32 s33, s17, 0x6000
  buffer_load_dwordx4 v201, s[4:7], s33 offen lds
  v_mfma_f32_16x16x32_bf16 v[0:3], v[160:163], v[120:123], v[0:3]
  v_mfma_f32_16x16x32_bf16 v[4:7], v[160:163], v[124:127], v[4:7]
  v_mfma_f32_16x16x32_bf16 v[8:11], v[160:163], v[128:131], v[8:11]
  v_mfma_f32_16x16x32_bf16 v[12:15], v[160:163], v[132:135], v[12:15]
  v_mfma_f32_16x16x32_bf16 v[16:19], v[160:163], v[136:139], v[16:19]
  v_mfma_f32_16x16x32_bf16 v[20:23], v[164:167], v[120:123], v[20:23]
  v_mfma_f32_16x16x32_bf16 v[24:27], v[164:167], v[124:127], v[24:27]
  v_mfma_f32_16x16x32_bf16 v[28:31], v[164:167], v[128:131], v[28:31]
  v_mfma_f32_16x16x32_bf16 v[32:35], v[164:167], v[132:135], v[32:35]
  v_mfma_f32_16x16x32_bf16 v[36:39], v[164:167], v[136:139], v[36:39]
  v_mfma_f32_16x16x32_bf16 v[40:43], v[168:171], v[120:123], v[40:43]
  v_mfma_f32_16x16x32_bf16 v[44:47], v[168:171], v[124:127], v[44:47]
  v_mfma_f32_16x16x32_bf16 v[48:51], v[168:171], v[128:131], v[48:51]
  v_mfma_f32_16x16x32_bf16 v[52:55], v[168:171], v[132:135], v[52:55]
  v_mfma_f32_16x16x32_bf16 v[56:59], v[168:171], v[136:139], v[56:59]
  v_mfma_f32_16x16x32_bf16 v[60:63], v[172:175], v[120:123], v[60:63]
  v_mfma_f32_16x16x32_bf16 v[64:67], v[172:175], v[124:127], v[64:67]
  v_mfma_f32_16x16x32_bf16 v[68:71], v[172:175], v[128:131], v[68:71]
  v_mfma_f32_16x16x32_bf16 v[72:75], v[172:175], v[132:135], v[72:75]
  v_mfma_f32_16x16x32_bf16 v[76:79], v[172:175], v[136:139], v[76:79]
  s_add_u32 s18, s16, 18
  s_and_b32 s18, s18, 31
  s_lshl_b32 s18, s18, 10
  buffer_load_dwordx4 v[120:123], v196, s[8:11], s18 offen
  buffer_load_dwordx4 v[124:127], v197, s[8:11], s18 offen
  buffer_load_dwordx4 v[128:131], v198, s[8:11], s18 offen
  buffer_load_dwordx4 v[132:135], v199, s[8:11], s18 offen
  buffer_load_dwordx4 v[136:139], v200, s[8:11], s18 offen
  s_waitcnt vmcnt(27)
  ds_read_b64_tr_b16 v[160:161], v192 offset:16384
  ds_read_b64_tr_b16 v[162:163], v192 offset:18432
  ds_read_b64_tr_b16 v[164:165], v193 offset:16384
  ds_read_b64_tr_b16 v[166:167], v193 offset:18432
  ds_read_b64_tr_b16 v[168:169], v194 offset:16384
  ds_read_b64_tr_b16 v[170:171], v194 offset:18432
  ds_read_b64_tr_b16 v[172:173], v195 offset:16384
  ds_read_b64_tr_b16 v[174:175], v195 offset:18432
  s_waitcnt lgkmcnt(8)
  s_add_u32 s17, s16, 20
  s_and_b32 s17, s17, 31
  s_lshl_b32 s17, s17, 15
  s_add_u32 m0, s43, 0x2000
  s_add_u32 s33, s17, 0x0
  buffer_load_dwordx4 v201, s[4:7], s33 offen lds
  s_add_u32 m0, s43, 0x2400
  s_add_u32 s33, s17, 0x2000
  buffer_load_dwordx4 v201, s[4:7], s33 offen lds
  s_add_u32 m0, s43, 0x2800
  s_add_u32 s33, s17, 0x4000
  buffer_load_dwordx4 v201, s[4:7], s33 offen lds
  s_add_u32 m0, s43, 0x2c00
  s_add_u32 s33, s17, 0x6000
  buffer_load_dwordx4 v201, s[4:7], s33 offen lds
  v_mfma_f32_16x16x32_bf16 v[0:3], v[176:179], v[140:143], v[0:3]
  v_mfma_f32_16x16x32_bf16 v[4:7], v[176:179], v[144:147], v[4:7]
  v_mfma_f32_16x16x32_bf16 v[8:11], v[176:179], v[148:151], v[8:11]
  v_mfma_f32_16x16x32_bf16 v[12:15], v[176:179], v[152:155], v[12:15]
  v_mfma_f32_16x16x32_bf16 v[16:19], v[176:179], v[156:159], v[16:19]
  v_mfma_f32_16x16x32_bf16 v[20:23], v[180:183], v[140:143], v[20:23]
  v_mfma_f32_16x16x32_bf16 v[24:27], v[180:183], v[144:147], v[24:27]
  v_mfma_f32_16x16x32_bf16 v[28:31], v[180:183], v[148:151], v[28:31]
  v_mfma_f32_16x16x32_bf16 v[32:35], v[180:183], v[152:155], v[32:35]
  v_mfma_f32_16x16x32_bf16 v[36:39], v[180:183], v[156:159], v[36:39]
  v_mfma_f32_16x16x32_bf16 v[40:43], v[184:187], v[140:143], v[40:43]
  v_mfma_f32_16x16x32_bf16 v[44:47], v[184:187], v[144:147], v[44:47]
  v_mfma_f32_16x16x32_bf16 v[48:51], v[184:187], v[148:151], v[48:51]
  v_mfma_f32_16x16x32_bf16 v[52:55], v[184:187], v[152:155], v[52:55]
  v_mfma_f32_16x16x32_bf16 v[56:59], v[184:187], v[156:159], v[56:59]
  v_mfma_f32_16x16x32_bf16 v[60:63], v[188:191], v[140:143], v[60:63]
  v_mfma_f32_16x16x32_bf16 v[64:67], v[188:191], v[144:147], v[64:67]
  v_mfma_f32_16x16x32_bf16 v[68:71], v[188:191], v[148:151], v[68:71]
  v_mfma_f32_16x16x32_bf16 v[72:75], v[188:191], v[152:155], v[72:75]
  v_mfma_f32_16x16x32_bf16 v[76:79], v[188:191], v[156:159], v[76:79]
  s_add_u32 s18, s16, 19
  s_and_b32 s18, s18, 31
  s_lshl_b32 s18, s18, 10
  buffer_load_dwordx4 v[140:143], v196, s[8:11], s18 offen
  buffer_load_dwordx4 v[144:147], v197, s[8:11], s18 offen
  buffer_load_dwordx4 v[148:151], v198, s[8:11], s18 offen
  buffer_load_dwordx4 v[152:155], v199, s[8:11], s18 offen
  buffer_load_dwordx4 v[156:159], v200, s[8:11], s18 offen
  s_waitcnt vmcnt(27)
  ds_read_b64_tr_b16 v[176:177], v192 offset:20480
  ds_read_b64_tr_b16 v[178:179], v192 offset:22528
  ds_read_b64_tr_b16 v[180:181], v193 offset:20480
  ds_read_b64_tr_b16 v[182:183], v193 offset:22528
  ds_read_b64_tr_b16 v[184:185], v194 offset:20480
  ds_read_b64_tr_b16 v[186:187], v194 offset:22528
  ds_read_b64_tr_b16 v[188:189], v195 offset:20480
  ds_read_b64_tr_b16 v[190:191], v195 offset:22528
  s_waitcnt lgkmcnt(8)
  s_add_u32 s17, s16, 21
  s_and_b32 s17, s17, 31
  s_lshl_b32 s17, s17, 15
  s_add_u32 m0, s43, 0x3000
  s_add_u32 s33, s17, 0x0
  buffer_load_dwordx4 v201, s[4:7], s33 offen lds
  s_add_u32 m0, s43, 0x3400
  s_add_u32 s33, s17, 0x2000
  buffer_load_dwordx4 v201, s[4:7], s33 offen lds
  s_add_u32 m0, s43, 0x3800
  s_add_u32 s33, s17, 0x4000
  buffer_load_dwordx4 v201, s[4:7], s33 offen lds
  s_add_u32 m0, s43, 0x3c00
  s_add_u32 s33, s17, 0x6000
  buffer_load_dwordx4 v201, s[4:7], s33 offen lds
  v_mfma_f32_16x16x32_bf16 v[0:3], v[160:163], v[80:83], v[0:3]
  v_mfma_f32_16x16x32_bf16 v[4:7], v[160:163], v[84:87], v[4:7]
  v_mfma_f32_16x16x32_bf16 v[8:11], v[160:163], v[88:91], v[8:11]
  v_mfma_f32_16x16x32_bf16 v[12:15], v[160:163], v[92:95], v[12:15]
  v_mfma_f32_16x16x32_bf16 v[16:19], v[160:163], v[96:99], v[16:19]
  v_mfma_f32_16x16x32_bf16 v[20:23], v[164:167], v[80:83], v[20:23]
  v_mfma_f32_16x16x32_bf16 v[24:27], v[164:167], v[84:87], v[24:27]
  v_mfma_f32_16x16x32_bf16 v[28:31], v[164:167], v[88:91], v[28:31]
  v_mfma_f32_16x16x32_bf16 v[32:35], v[164:167], v[92:95], v[32:35]
  v_mfma_f32_16x16x32_bf16 v[36:39], v[164:167], v[96:99], v[36:39]
  v_mfma_f32_16x16x32_bf16 v[40:43], v[168:171], v[80:83], v[40:43]
  v_mfma_f32_16x16x32_bf16 v[44:47], v[168:171], v[84:87], v[44:47]
  v_mfma_f32_16x16x32_bf16 v[48:51], v[168:171], v[88:91], v[48:51]
  v_mfma_f32_16x16x32_bf16 v[52:55], v[168:171], v[92:95], v[52:55]
  v_mfma_f32_16x16x32_bf16 v[56:59], v[168:171], v[96:99], v[56:59]
  v_mfma_f32_16x16x32_bf16 v[60:63], v[172:175], v[80:83], v[60:63]
  v_mfma_f32_16x16x32_bf16 v[64:67], v[172:175], v[84:87], v[64:67]
  v_mfma_f32_16x16x32_bf16 v[68:71], v[172:175], v[88:91], v[68:71]
  v_mfma_f32_16x16x32_bf16 v[72:75], v[172:175], v[92:95], v[72:75]
  v_mfma_f32_16x16x32_bf16 v[76:79], v[172:175], v[96:99], v[76:79]
  s_add_u32 s18, s16, 20
  s_and_b32 s18, s18, 31
  s_lshl_b32 s18, s18, 10
  buffer_load_dwordx4 v[80:83], v196, s[8:11], s18 offen
  buffer_load_dwordx4 v[84:87], v197, s[8:11], s18 offen
  buffer_load_dwordx4 v[88:91], v198, s[8:11], s18 offen
  buffer_load_dwordx4 v[92:95], v199, s[8:11], s18 offen
  buffer_load_dwordx4 v[96:99], v200, s[8:11], s18 offen
  s_waitcnt vmcnt(27)
  ds_read_b64_tr_b16 v[160:161], v192 offset:0
  ds_read_b64_tr_b16 v[162:163], v192 offset:2048
  ds_read_b64_tr_b16 v[164:165], v193 offset:0
  ds_read_b64_tr_b16 v[166:167], v193 offset:2048
  ds_read_b64_tr_b16 v[168:169], v194 offset:0
  ds_read_b64_tr_b16 v[170:171], v194 offset:2048
  ds_read_b64_tr_b16 v[172:173], v195 offset:0
  ds_read_b64_tr_b16 v[174:175], v195 offset:2048
  s_waitcnt lgkmcnt(8)
  s_add_u32 s17, s16, 22
  s_and_b32 s17, s17, 31
  s_lshl_b32 s17, s17, 15
  s_add_u32 m0, s43, 0x4000
  s_add_u32 s33, s17, 0x0
  buffer_load_dwordx4 v201, s[4:7], s33 offen lds
  s_add_u32 m0, s43, 0x4400
  s_add_u32 s33, s17, 0x2000
  buffer_load_dwordx4 v201, s[4:7], s33 offen lds
  s_add_u32 m0, s43, 0x4800
  s_add_u32 s33, s17, 0x4000
  buffer_load_dwordx4 v201, s[4:7], s33 offen lds
  s_add_u32 m0, s43, 0x4c00
  s_add_u32 s33, s17, 0x6000
  buffer_load_dwordx4 v201, s[4:7], s33 offen lds
  v_mfma_f32_16x16x32_bf16 v[0:3], v[176:179], v[100:103], v[0:3]
  v_mfma_f32_16x16x32_bf16 v[4:7], v[176:179], v[104:107], v[4:7]
  v_mfma_f32_16x16x32_bf16 v[8:11], v[176:179], v[108:111], v[8:11]
  v_mfma_f32_16x16x32_bf16 v[12:15], v[176:179], v[112:115], v[12:15]
  v_mfma_f32_16x16x32_bf16 v[16:19], v[176:179], v[116:119], v[16:19]
  v_mfma_f32_16x16x32_bf16 v[20:23], v[180:183], v[100:103], v[20:23]
  v_mfma_f32_16x16x32_bf16 v[24:27], v[180:183], v[104:107], v[24:27]
  v_mfma_f32_16x16x32_bf16 v[28:31], v[180:183], v[108:111], v[28:31]
  v_mfma_f32_16x16x32_bf16 v[32:35], v[180:183], v[112:115], v[32:35]
  v_mfma_f32_16x16x32_bf16 v[36:39], v[180:183], v[116:119], v[36:39]
  v_mfma_f32_16x16x32_bf16 v[40:43], v[184:187], v[100:103], v[40:43]
  v_mfma_f32_16x16x32_bf16 v[44:47], v[184:187], v[104:107], v[44:47]
  v_mfma_f32_16x16x32_bf16 v[48:51], v[184:187], v[108:111], v[48:51]
  v_mfma_f32_16x16x32_bf16 v[52:55], v[184:187], v[112:115], v[52:55]
  v_mfma_f32_16x16x32_bf16 v[56:59], v[184:187], v[116:119], v[56:59]
  v_mfma_f32_16x16x32_bf16 v[60:63], v[188:191], v[100:103], v[60:63]
  v_mfma_f32_16x16x32_bf16 v[64:67], v[188:191], v[104:107], v[64:67]
  v_mfma_f32_16x16x32_bf16 v[68:71], v[188:191], v[108:111], v[68:71]
  v_mfma_f32_16x16x32_bf16 v[72:75], v[188:191], v[112:115], v[72:75]
  v_mfma_f32_16x16x32_bf16 v[76:79], v[188:191], v[116:119], v[76:79]
  s_add_u32 s18, s16, 21
  s_and_b32 s18, s18, 31
  s_lshl_b32 s18, s18, 10
  buffer_load_dwordx4 v[100:103], v196, s[8:11], s18 offen
  buffer_load_dwordx4 v[104:107], v197, s[8:11], s18 offen
  buffer_load_dwordx4 v[108:111], v198, s[8:11], s18 offen
  buffer_load_dwordx4 v[112:115], v199, s[8:11], s18 offen
  buffer_load_dwordx4 v[116:119], v200, s[8:11], s18 offen
  s_waitcnt vmcnt(27)
  ds_read_b64_tr_b16 v[176:177], v192 offset:4096
  ds_read_b64_tr_b16 v[178:179], v192 offset:6144
  ds_read_b64_tr_b16 v[180:181], v193 offset:4096
  ds_read_b64_tr_b16 v[182:183], v193 offset:6144
  ds_read_b64_tr_b16 v[184:185], v194 offset:4096
  ds_read_b64_tr_b16 v[186:187], v194 offset:6144
  ds_read_b64_tr_b16 v[188:189], v195 offset:4096
  ds_read_b64_tr_b16 v[190:191], v195 offset:6144
  s_waitcnt lgkmcnt(8)
  s_add_u32 s17, s16, 23
  s_and_b32 s17, s17, 31
  s_lshl_b32 s17, s17, 15
  s_add_u32 m0, s43, 0x5000
  s_add_u32 s33, s17, 0x0
  buffer_load_dwordx4 v201, s[4:7], s33 offen lds
  s_add_u32 m0, s43, 0x5400
  s_add_u32 s33, s17, 0x2000
  buffer_load_dwordx4 v201, s[4:7], s33 offen lds
  s_add_u32 m0, s43, 0x5800
  s_add_u32 s33, s17, 0x4000
  buffer_load_dwordx4 v201, s[4:7], s33 offen lds
  s_add_u32 m0, s43, 0x5c00
  s_add_u32 s33, s17, 0x6000
  buffer_load_dwordx4 v201, s[4:7], s33 offen lds
  v_mfma_f32_16x16x32_bf16 v[0:3], v[160:163], v[120:123], v[0:3]
  v_mfma_f32_16x16x32_bf16 v[4:7], v[160:163], v[124:127], v[4:7]
  v_mfma_f32_16x16x32_bf16 v[8:11], v[160:163], v[128:131], v[8:11]
  v_mfma_f32_16x16x32_bf16 v[12:15], v[160:163], v[132:135], v[12:15]
  v_mfma_f32_16x16x32_bf16 v[16:19], v[160:163], v[136:139], v[16:19]
  v_mfma_f32_16x16x32_bf16 v[20:23], v[164:167], v[120:123], v[20:23]
  v_mfma_f32_16x16x32_bf16 v[24:27], v[164:167], v[124:127], v[24:27]
  v_mfma_f32_16x16x32_bf16 v[28:31], v[164:167], v[128:131], v[28:31]
  v_mfma_f32_16x16x32_bf16 v[32:35], v[164:167], v[132:135], v[32:35]
  v_mfma_f32_16x16x32_bf16 v[36:39], v[164:167], v[136:139], v[36:39]
  v_mfma_f32_16x16x32_bf16 v[40:43], v[168:171], v[120:123], v[40:43]
  v_mfma_f32_16x16x32_bf16 v[44:47], v[168:171], v[124:127], v[44:47]
  v_mfma_f32_16x16x32_bf16 v[48:51], v[168:171], v[128:131], v[48:51]
  v_mfma_f32_16x16x32_bf16 v[52:55], v[168:171], v[132:135], v[52:55]
  v_mfma_f32_16x16x32_bf16 v[56:59], v[168:171], v[136:139], v[56:59]
  v_mfma_f32_16x16x32_bf16 v[60:63], v[172:175], v[120:123], v[60:63]
  v_mfma_f32_16x16x32_bf16 v[64:67], v[172:175], v[124:127], v[64:67]
  v_mfma_f32_16x16x32_bf16 v[68:71], v[172:175], v[128:131], v[68:71]
  v_mfma_f32_16x16x32_bf16 v[72:75], v[172:175], v[132:135], v[72:75]
  v_mfma_f32_16x16x32_bf16 v[76:79], v[172:175], v[136:139], v[76:79]
  s_add_u32 s18, s16, 22
  s_and_b32 s18, s18, 31
  s_lshl_b32 s18, s18, 10
  buffer_load_dwordx4 v[120:123], v196, s[8:11], s18 offen
  buffer_load_dwordx4 v[124:127], v197, s[8:11], s18 offen
  buffer_load_dwordx4 v[128:131], v198, s[8:11], s18 offen
  buffer_load_dwordx4 v[132:135], v199, s[8:11], s18 offen
  buffer_load_dwordx4 v[136:139], v200, s[8:11], s18 offen
  s_waitcnt vmcnt(27)
  ds_read_b64_tr_b16 v[160:161], v192 offset:8192
  ds_read_b64_tr_b16 v[162:163], v192 offset:10240
  ds_read_b64_tr_b16 v[164:165], v193 offset:8192
  ds_read_b64_tr_b16 v[166:167], v193 offset:10240
  ds_read_b64_tr_b16 v[168:169], v194 offset:8192
  ds_read_b64_tr_b16 v[170:171], v194 offset:10240
  ds_read_b64_tr_b16 v[172:173], v195 offset:8192
  ds_read_b64_tr_b16 v[174:175], v195 offset:10240
  s_waitcnt lgkmcnt(8)
  s_add_u32 s17, s16, 24
  s_and_b32 s17, s17, 31
  s_lshl_b32 s17, s17, 15
  s_add_u32 m0, s43, 0x0
  s_add_u32 s33, s17, 0x0
  buffer_load_dwordx4 v201, s[4:7], s33 offen lds
  s_add_u32 m0, s43, 0x400
  s_add_u32 s33, s17, 0x2000
  buffer_load_dwordx4 v201, s[4:7], s33 offen lds
  s_add_u32 m0, s43, 0x800
  s_add_u32 s33, s17, 0x4000
  buffer_load_dwordx4 v201, s[4:7], s33 offen lds
  s_add_u32 m0, s43, 0xc00
  s_add_u32 s33, s17, 0x6000
  buffer_load_dwordx4 v201, s[4:7], s33 offen lds
  v_mfma_f32_16x16x32_bf16 v[0:3], v[176:179], v[140:143], v[0:3]
  v_mfma_f32_16x16x32_bf16 v[4:7], v[176:179], v[144:147], v[4:7]
  v_mfma_f32_16x16x32_bf16 v[8:11], v[176:179], v[148:151], v[8:11]
  v_mfma_f32_16x16x32_bf16 v[12:15], v[176:179], v[152:155], v[12:15]
  v_mfma_f32_16x16x32_bf16 v[16:19], v[176:179], v[156:159], v[16:19]
  v_mfma_f32_16x16x32_bf16 v[20:23], v[180:183], v[140:143], v[20:23]
  v_mfma_f32_16x16x32_bf16 v[24:27], v[180:183], v[144:147], v[24:27]
  v_mfma_f32_16x16x32_bf16 v[28:31], v[180:183], v[148:151], v[28:31]
  v_mfma_f32_16x16x32_bf16 v[32:35], v[180:183], v[152:155], v[32:35]
  v_mfma_f32_16x16x32_bf16 v[36:39], v[180:183], v[156:159], v[36:39]
  v_mfma_f32_16x16x32_bf16 v[40:43], v[184:187], v[140:143], v[40:43]
  v_mfma_f32_16x16x32_bf16 v[44:47], v[184:187], v[144:147], v[44:47]
  v_mfma_f32_16x16x32_bf16 v[48:51], v[184:187], v[148:151], v[48:51]
  v_mfma_f32_16x16x32_bf16 v[52:55], v[184:187], v[152:155], v[52:55]
  v_mfma_f32_16x16x32_bf16 v[56:59], v[184:187], v[156:159], v[56:59]
  v_mfma_f32_16x16x32_bf16 v[60:63], v[188:191], v[140:143], v[60:63]
  v_mfma_f32_16x16x32_bf16 v[64:67], v[188:191], v[144:147], v[64:67]
  v_mfma_f32_16x16x32_bf16 v[68:71], v[188:191], v[148:151], v[68:71]
  v_mfma_f32_16x16x32_bf16 v[72:75], v[188:191], v[152:155], v[72:75]
  v_mfma_f32_16x16x32_bf16 v[76:79], v[188:191], v[156:159], v[76:79]
  s_add_u32 s18, s16, 23
  s_and_b32 s18, s18, 31
  s_lshl_b32 s18, s18, 10
  buffer_load_dwordx4 v[140:143], v196, s[8:11], s18 offen
  buffer_load_dwordx4 v[144:147], v197, s[8:11], s18 offen
  buffer_load_dwordx4 v[148:151], v198, s[8:11], s18 offen
  buffer_load_dwordx4 v[152:155], v199, s[8:11], s18 offen
  buffer_load_dwordx4 v[156:159], v200, s[8:11], s18 offen
  s_waitcnt vmcnt(27)
  ds_read_b64_tr_b16 v[176:177], v192 offset:12288
  ds_read_b64_tr_b16 v[178:179], v192 offset:14336
  ds_read_b64_tr_b16 v[180:181], v193 offset:12288
  ds_read_b64_tr_b16 v[182:183], v193 offset:14336
  ds_read_b64_tr_b16 v[184:185], v194 offset:12288
  ds_read_b64_tr_b16 v[186:187], v194 offset:14336
  ds_read_b64_tr_b16 v[188:189], v195 offset:12288
  ds_read_b64_tr_b16 v[190:191], v195 offset:14336
  s_waitcnt lgkmcnt(8)
  s_add_u32 s17, s16, 25
  s_and_b32 s17, s17, 31
  s_lshl_b32 s17, s17, 15
  s_add_u32 m0, s43, 0x1000
  s_add_u32 s33, s17, 0x0
  buffer_load_dwordx4 v201, s[4:7], s33 offen lds
  s_add_u32 m0, s43, 0x1400
  s_add_u32 s33, s17, 0x2000
  buffer_load_dwordx4 v201, s[4:7], s33 offen lds
  s_add_u32 m0, s43, 0x1800
  s_add_u32 s33, s17, 0x4000
  buffer_load_dwordx4 v201, s[4:7], s33 offen lds
  s_add_u32 m0, s43, 0x1c00
  s_add_u32 s33, s17, 0x6000
  buffer_load_dwordx4 v201, s[4:7], s33 offen lds
  v_mfma_f32_16x16x32_bf16 v[0:3], v[160:163], v[80:83], v[0:3]
  v_mfma_f32_16x16x32_bf16 v[4:7], v[160:163], v[84:87], v[4:7]
  v_mfma_f32_16x16x32_bf16 v[8:11], v[160:163], v[88:91], v[8:11]
  v_mfma_f32_16x16x32_bf16 v[12:15], v[160:163], v[92:95], v[12:15]
  v_mfma_f32_16x16x32_bf16 v[16:19], v[160:163], v[96:99], v[16:19]
  v_mfma_f32_16x16x32_bf16 v[20:23], v[164:167], v[80:83], v[20:23]
  v_mfma_f32_16x16x32_bf16 v[24:27], v[164:167], v[84:87], v[24:27]
  v_mfma_f32_16x16x32_bf16 v[28:31], v[164:167], v[88:91], v[28:31]
  v_mfma_f32_16x16x32_bf16 v[32:35], v[164:167], v[92:95], v[32:35]
  v_mfma_f32_16x16x32_bf16 v[36:39], v[164:167], v[96:99], v[36:39]
  v_mfma_f32_16x16x32_bf16 v[40:43], v[168:171], v[80:83], v[40:43]
  v_mfma_f32_16x16x32_bf16 v[44:47], v[168:171], v[84:87], v[44:47]
  v_mfma_f32_16x16x32_bf16 v[48:51], v[168:171], v[88:91], v[48:51]
  v_mfma_f32_16x16x32_bf16 v[52:55], v[168:171], v[92:95], v[52:55]
  v_mfma_f32_16x16x32_bf16 v[56:59], v[168:171], v[96:99], v[56:59]
  v_mfma_f32_16x16x32_bf16 v[60:63], v[172:175], v[80:83], v[60:63]
  v_mfma_f32_16x16x32_bf16 v[64:67], v[172:175], v[84:87], v[64:67]
  v_mfma_f32_16x16x32_bf16 v[68:71], v[172:175], v[88:91], v[68:71]
  v_mfma_f32_16x16x32_bf16 v[72:75], v[172:175], v[92:95], v[72:75]
  v_mfma_f32_16x16x32_bf16 v[76:79], v[172:175], v[96:99], v[76:79]
  s_add_u32 s18, s16, 24
  s_and_b32 s18, s18, 31
  s_lshl_b32 s18, s18, 10
  buffer_load_dwordx4 v[80:83], v196, s[8:11], s18 offen
  buffer_load_dwordx4 v[84:87], v197, s[8:11], s18 offen
  buffer_load_dwordx4 v[88:91], v198, s[8:11], s18 offen
  buffer_load_dwordx4 v[92:95], v199, s[8:11], s18 offen
  buffer_load_dwordx4 v[96:99], v200, s[8:11], s18 offen
  s_waitcnt vmcnt(27)
  ds_read_b64_tr_b16 v[160:161], v192 offset:16384
  ds_read_b64_tr_b16 v[162:163], v192 offset:18432
  ds_read_b64_tr_b16 v[164:165], v193 offset:16384
  ds_read_b64_tr_b16 v[166:167], v193 offset:18432
  ds_read_b64_tr_b16 v[168:169], v194 offset:16384
  ds_read_b64_tr_b16 v[170:171], v194 offset:18432
  ds_read_b64_tr_b16 v[172:173], v195 offset:16384
  ds_read_b64_tr_b16 v[174:175], v195 offset:18432
  s_waitcnt lgkmcnt(8)
  s_add_u32 s17, s16, 26
  s_and_b32 s17, s17, 31
  s_lshl_b32 s17, s17, 15
  s_add_u32 m0, s43, 0x2000
  s_add_u32 s33, s17, 0x0
  buffer_load_dwordx4 v201, s[4:7], s33 offen lds
  s_add_u32 m0, s43, 0x2400
  s_add_u32 s33, s17, 0x2000
  buffer_load_dwordx4 v201, s[4:7], s33 offen lds
  s_add_u32 m0, s43, 0x2800
  s_add_u32 s33, s17, 0x4000
  buffer_load_dwordx4 v201, s[4:7], s33 offen lds
  s_add_u32 m0, s43, 0x2c00
  s_add_u32 s33, s17, 0x6000
  buffer_load_dwordx4 v201, s[4:7], s33 offen lds
  v_mfma_f32_16x16x32_bf16 v[0:3], v[176:179], v[100:103], v[0:3]
  v_mfma_f32_16x16x32_bf16 v[4:7], v[176:179], v[104:107], v[4:7]
  v_mfma_f32_16x16x32_bf16 v[8:11], v[176:179], v[108:111], v[8:11]
  v_mfma_f32_16x16x32_bf16 v[12:15], v[176:179], v[112:115], v[12:15]
  v_mfma_f32_16x16x32_bf16 v[16:19], v[176:179], v[116:119], v[16:19]
  v_mfma_f32_16x16x32_bf16 v[20:23], v[180:183], v[100:103], v[20:23]
  v_mfma_f32_16x16x32_bf16 v[24:27], v[180:183], v[104:107], v[24:27]
  v_mfma_f32_16x16x32_bf16 v[28:31], v[180:183], v[108:111], v[28:31]
  v_mfma_f32_16x16x32_bf16 v[32:35], v[180:183], v[112:115], v[32:35]
  v_mfma_f32_16x16x32_bf16 v[36:39], v[180:183], v[116:119], v[36:39]
  v_mfma_f32_16x16x32_bf16 v[40:43], v[184:187], v[100:103], v[40:43]
  v_mfma_f32_16x16x32_bf16 v[44:47], v[184:187], v[104:107], v[44:47]
  v_mfma_f32_16x16x32_bf16 v[48:51], v[184:187], v[108:111], v[48:51]
  v_mfma_f32_16x16x32_bf16 v[52:55], v[184:187], v[112:115], v[52:55]
  v_mfma_f32_16x16x32_bf16 v[56:59], v[184:187], v[116:119], v[56:59]
  v_mfma_f32_16x16x32_bf16 v[60:63], v[188:191], v[100:103], v[60:63]
  v_mfma_f32_16x16x32_bf16 v[64:67], v[188:191], v[104:107], v[64:67]
  v_mfma_f32_16x16x32_bf16 v[68:71], v[188:191], v[108:111], v[68:71]
  v_mfma_f32_16x16x32_bf16 v[72:75], v[188:191], v[112:115], v[72:75]
  v_mfma_f32_16x16x32_bf16 v[76:79], v[188:191], v[116:119], v[76:79]
  s_add_u32 s18, s16, 25
  s_and_b32 s18, s18, 31
  s_lshl_b32 s18, s18, 10
  buffer_load_dwordx4 v[100:103], v196, s[8:11], s18 offen
  buffer_load_dwordx4 v[104:107], v197, s[8:11], s18 offen
  buffer_load_dwordx4 v[108:111], v198, s[8:11], s18 offen
  buffer_load_dwordx4 v[112:115], v199, s[8:11], s18 offen
  buffer_load_dwordx4 v[116:119], v200, s[8:11], s18 offen
  s_waitcnt vmcnt(27)
  ds_read_b64_tr_b16 v[176:177], v192 offset:20480
  ds_read_b64_tr_b16 v[178:179], v192 offset:22528
  ds_read_b64_tr_b16 v[180:181], v193 offset:20480
  ds_read_b64_tr_b16 v[182:183], v193 offset:22528
  ds_read_b64_tr_b16 v[184:185], v194 offset:20480
  ds_read_b64_tr_b16 v[186:187], v194 offset:22528
  ds_read_b64_tr_b16 v[188:189], v195 offset:20480
  ds_read_b64_tr_b16 v[190:191], v195 offset:22528
  s_waitcnt lgkmcnt(8)
  s_add_u32 s17, s16, 27
  s_and_b32 s17, s17, 31
  s_lshl_b32 s17, s17, 15
  s_add_u32 m0, s43, 0x3000
  s_add_u32 s33, s17, 0x0
  buffer_load_dwordx4 v201, s[4:7], s33 offen lds
  s_add_u32 m0, s43, 0x3400
  s_add_u32 s33, s17, 0x2000
  buffer_load_dwordx4 v201, s[4:7], s33 offen lds
  s_add_u32 m0, s43, 0x3800
  s_add_u32 s33, s17, 0x4000
  buffer_load_dwordx4 v201, s[4:7], s33 offen lds
  s_add_u32 m0, s43, 0x3c00
  s_add_u32 s33, s17, 0x6000
  buffer_load_dwordx4 v201, s[4:7], s33 offen lds
  v_mfma_f32_16x16x32_bf16 v[0:3], v[160:163], v[120:123], v[0:3]
  v_mfma_f32_16x16x32_bf16 v[4:7], v[160:163], v[124:127], v[4:7]
  v_mfma_f32_16x16x32_bf16 v[8:11], v[160:163], v[128:131], v[8:11]
  v_mfma_f32_16x16x32_bf16 v[12:15], v[160:163], v[132:135], v[12:15]
  v_mfma_f32_16x16x32_bf16 v[16:19], v[160:163], v[136:139], v[16:19]
  v_mfma_f32_16x16x32_bf16 v[20:23], v[164:167], v[120:123], v[20:23]
  v_mfma_f32_16x16x32_bf16 v[24:27], v[164:167], v[124:127], v[24:27]
  v_mfma_f32_16x16x32_bf16 v[28:31], v[164:167], v[128:131], v[28:31]
  v_mfma_f32_16x16x32_bf16 v[32:35], v[164:167], v[132:135], v[32:35]
  v_mfma_f32_16x16x32_bf16 v[36:39], v[164:167], v[136:139], v[36:39]
  v_mfma_f32_16x16x32_bf16 v[40:43], v[168:171], v[120:123], v[40:43]
  v_mfma_f32_16x16x32_bf16 v[44:47], v[168:171], v[124:127], v[44:47]
  v_mfma_f32_16x16x32_bf16 v[48:51], v[168:171], v[128:131], v[48:51]
  v_mfma_f32_16x16x32_bf16 v[52:55], v[168:171], v[132:135], v[52:55]
  v_mfma_f32_16x16x32_bf16 v[56:59], v[168:171], v[136:139], v[56:59]
  v_mfma_f32_16x16x32_bf16 v[60:63], v[172:175], v[120:123], v[60:63]
  v_mfma_f32_16x16x32_bf16 v[64:67], v[172:175], v[124:127], v[64:67]
  v_mfma_f32_16x16x32_bf16 v[68:71], v[172:175], v[128:131], v[68:71]
  v_mfma_f32_16x16x32_bf16 v[72:75], v[172:175], v[132:135], v[72:75]
  v_mfma_f32_16x16x32_bf16 v[76:79], v[172:175], v[136:139], v[76:79]
  s_add_u32 s18, s16, 26
  s_and_b32 s18, s18, 31
  s_lshl_b32 s18, s18, 10
  buffer_load_dwordx4 v[120:123], v196, s[8:11], s18 offen
  buffer_load_dwordx4 v[124:127], v197, s[8:11], s18 offen
  buffer_load_dwordx4 v[128:131], v198, s[8:11], s18 offen
  buffer_load_dwordx4 v[132:135], v199, s[8:11], s18 offen
  buffer_load_dwordx4 v[136:139], v200, s[8:11], s18 offen
  s_waitcnt vmcnt(27)
  ds_read_b64_tr_b16 v[160:161], v192 offset:0
  ds_read_b64_tr_b16 v[162:163], v192 offset:2048
  ds_read_b64_tr_b16 v[164:165], v193 offset:0
  ds_read_b64_tr_b16 v[166:167], v193 offset:2048
  ds_read_b64_tr_b16 v[168:169], v194 offset:0
  ds_read_b64_tr_b16 v[170:171], v194 offset:2048
  ds_read_b64_tr_b16 v[172:173], v195 offset:0
  ds_read_b64_tr_b16 v[174:175], v195 offset:2048
  s_waitcnt lgkmcnt(8)
  s_add_u32 s17, s16, 28
  s_and_b32 s17, s17, 31
  s_lshl_b32 s17, s17, 15
  s_add_u32 m0, s43, 0x4000
  s_add_u32 s33, s17, 0x0
  buffer_load_dwordx4 v201, s[4:7], s33 offen lds
  s_add_u32 m0, s43, 0x4400
  s_add_u32 s33, s17, 0x2000
  buffer_load_dwordx4 v201, s[4:7], s33 offen lds
  s_add_u32 m0, s43, 0x4800
  s_add_u32 s33, s17, 0x4000
  buffer_load_dwordx4 v201, s[4:7], s33 offen lds
  s_add_u32 m0, s43, 0x4c00
  s_add_u32 s33, s17, 0x6000
  buffer_load_dwordx4 v201, s[4:7], s33 offen lds
  v_mfma_f32_16x16x32_bf16 v[0:3], v[176:179], v[140:143], v[0:3]
  v_mfma_f32_16x16x32_bf16 v[4:7], v[176:179], v[144:147], v[4:7]
  v_mfma_f32_16x16x32_bf16 v[8:11], v[176:179], v[148:151], v[8:11]
  v_mfma_f32_16x16x32_bf16 v[12:15], v[176:179], v[152:155], v[12:15]
  v_mfma_f32_16x16x32_bf16 v[16:19], v[176:179], v[156:159], v[16:19]
  v_mfma_f32_16x16x32_bf16 v[20:23], v[180:183], v[140:143], v[20:23]
  v_mfma_f32_16x16x32_bf16 v[24:27], v[180:183], v[144:147], v[24:27]
  v_mfma_f32_16x16x32_bf16 v[28:31], v[180:183], v[148:151], v[28:31]
  v_mfma_f32_16x16x32_bf16 v[32:35], v[180:183], v[152:155], v[32:35]
  v_mfma_f32_16x16x32_bf16 v[36:39], v[180:183], v[156:159], v[36:39]
  v_mfma_f32_16x16x32_bf16 v[40:43], v[184:187], v[140:143], v[40:43]
  v_mfma_f32_16x16x32_bf16 v[44:47], v[184:187], v[144:147], v[44:47]
  v_mfma_f32_16x16x32_bf16 v[48:51], v[184:187], v[148:151], v[48:51]
  v_mfma_f32_16x16x32_bf16 v[52:55], v[184:187], v[152:155], v[52:55]
  v_mfma_f32_16x16x32_bf16 v[56:59], v[184:187], v[156:159], v[56:59]
  v_mfma_f32_16x16x32_bf16 v[60:63], v[188:191], v[140:143], v[60:63]
  v_mfma_f32_16x16x32_bf16 v[64:67], v[188:191], v[144:147], v[64:67]
  v_mfma_f32_16x16x32_bf16 v[68:71], v[188:191], v[148:151], v[68:71]
  v_mfma_f32_16x16x32_bf16 v[72:75], v[188:191], v[152:155], v[72:75]
  v_mfma_f32_16x16x32_bf16 v[76:79], v[188:191], v[156:159], v[76:79]
  s_add_u32 s18, s16, 27
  s_and_b32 s18, s18, 31
  s_lshl_b32 s18, s18, 10
  buffer_load_dwordx4 v[140:143], v196, s[8:11], s18 offen
  buffer_load_dwordx4 v[144:147], v197, s[8:11], s18 offen
  buffer_load_dwordx4 v[148:151], v198, s[8:11], s18 offen
  buffer_load_dwordx4 v[152:155], v199, s[8:11], s18 offen
  buffer_load_dwordx4 v[156:159], v200, s[8:11], s18 offen
  s_waitcnt vmcnt(27)
  ds_read_b64_tr_b16 v[176:177], v192 offset:4096
  ds_read_b64_tr_b16 v[178:179], v192 offset:6144
  ds_read_b64_tr_b16 v[180:181], v193 offset:4096
  ds_read_b64_tr_b16 v[182:183], v193 offset:6144
  ds_read_b64_tr_b16 v[184:185], v194 offset:4096
  ds_read_b64_tr_b16 v[186:187], v194 offset:6144
  ds_read_b64_tr_b16 v[188:189], v195 offset:4096
  ds_read_b64_tr_b16 v[190:191], v195 offset:6144
  s_waitcnt lgkmcnt(8)
  s_add_u32 s17, s16, 29
  s_and_b32 s17, s17, 31
  s_lshl_b32 s17, s17, 15
  s_add_u32 m0, s43, 0x5000
  s_add_u32 s33, s17, 0x0
  buffer_load_dwordx4 v201, s[4:7], s33 offen lds
  s_add_u32 m0, s43, 0x5400
  s_add_u32 s33, s17, 0x2000
  buffer_load_dwordx4 v201, s[4:7], s33 offen lds
  s_add_u32 m0, s43, 0x5800
  s_add_u32 s33, s17, 0x4000
  buffer_load_dwordx4 v201, s[4:7], s33 offen lds
  s_add_u32 m0, s43, 0x5c00
  s_add_u32 s33, s17, 0x6000
  buffer_load_dwordx4 v201, s[4:7], s33 offen lds
  v_mfma_f32_16x16x32_bf16 v[0:3], v[160:163], v[80:83], v[0:3]
  v_mfma_f32_16x16x32_bf16 v[4:7], v[160:163], v[84:87], v[4:7]
  v_mfma_f32_16x16x32_bf16 v[8:11], v[160:163], v[88:91], v[8:11]
  v_mfma_f32_16x16x32_bf16 v[12:15], v[160:163], v[92:95], v[12:15]
  v_mfma_f32_16x16x32_bf16 v[16:19], v[160:163], v[96:99], v[16:19]
  v_mfma_f32_16x16x32_bf16 v[20:23], v[164:167], v[80:83], v[20:23]
  v_mfma_f32_16x16x32_bf16 v[24:27], v[164:167], v[84:87], v[24:27]
  v_mfma_f32_16x16x32_bf16 v[28:31], v[164:167], v[88:91], v[28:31]
  v_mfma_f32_16x16x32_bf16 v[32:35], v[164:167], v[92:95], v[32:35]
  v_mfma_f32_16x16x32_bf16 v[36:39], v[164:167], v[96:99], v[36:39]
  v_mfma_f32_16x16x32_bf16 v[40:43], v[168:171], v[80:83], v[40:43]
  v_mfma_f32_16x16x32_bf16 v[44:47], v[168:171], v[84:87], v[44:47]
  v_mfma_f32_16x16x32_bf16 v[48:51], v[168:171], v[88:91], v[48:51]
  v_mfma_f32_16x16x32_bf16 v[52:55], v[168:171], v[92:95], v[52:55]
  v_mfma_f32_16x16x32_bf16 v[56:59], v[168:171], v[96:99], v[56:59]
  v_mfma_f32_16x16x32_bf16 v[60:63], v[172:175], v[80:83], v[60:63]
  v_mfma_f32_16x16x32_bf16 v[64:67], v[172:175], v[84:87], v[64:67]
  v_mfma_f32_16x16x32_bf16 v[68:71], v[172:175], v[88:91], v[68:71]
  v_mfma_f32_16x16x32_bf16 v[72:75], v[172:175], v[92:95], v[72:75]
  v_mfma_f32_16x16x32_bf16 v[76:79], v[172:175], v[96:99], v[76:79]
  s_add_u32 s18, s16, 28
  s_and_b32 s18, s18, 31
  s_lshl_b32 s18, s18, 10
  buffer_load_dwordx4 v[80:83], v196, s[8:11], s18 offen
  buffer_load_dwordx4 v[84:87], v197, s[8:11], s18 offen
  buffer_load_dwordx4 v[88:91], v198, s[8:11], s18 offen
  buffer_load_dwordx4 v[92:95], v199, s[8:11], s18 offen
  buffer_load_dwordx4 v[96:99], v200, s[8:11], s18 offen
  s_waitcnt vmcnt(27)
  ds_read_b64_tr_b16 v[160:161], v192 offset:8192
  ds_read_b64_tr_b16 v[162:163], v192 offset:10240
  ds_read_b64_tr_b16 v[164:165], v193 offset:8192
  ds_read_b64_tr_b16 v[166:167], v193 offset:10240
  ds_read_b64_tr_b16 v[168:169], v194 offset:8192
  ds_read_b64_tr_b16 v[170:171], v194 offset:10240
  ds_read_b64_tr_b16 v[172:173], v195 offset:8192
  ds_read_b64_tr_b16 v[174:175], v195 offset:10240
  s_waitcnt lgkmcnt(8)
  s_add_u32 s17, s16, 30
  s_and_b32 s17, s17, 31
  s_lshl_b32 s17, s17, 15
  s_add_u32 m0, s43, 0x0
  s_add_u32 s33, s17, 0x0
  buffer_load_dwordx4 v201, s[4:7], s33 offen lds
  s_add_u32 m0, s43, 0x400
  s_add_u32 s33, s17, 0x2000
  buffer_load_dwordx4 v201, s[4:7], s33 offen lds
  s_add_u32 m0, s43, 0x800
  s_add_u32 s33, s17, 0x4000
  buffer_load_dwordx4 v201, s[4:7], s33 offen lds
  s_add_u32 m0, s43, 0xc00
  s_add_u32 s33, s17, 0x6000
  buffer_load_dwordx4 v201, s[4:7], s33 offen lds
  v_mfma_f32_16x16x32_bf16 v[0:3], v[176:179], v[100:103], v[0:3]
  v_mfma_f32_16x16x32_bf16 v[4:7], v[176:179], v[104:107], v[4:7]
  v_mfma_f32_16x16x32_bf16 v[8:11], v[176:179], v[108:111], v[8:11]
  v_mfma_f32_16x16x32_bf16 v[12:15], v[176:179], v[112:115], v[12:15]
  v_mfma_f32_16x16x32_bf16 v[16:19], v[176:179], v[116:119], v[16:19]
  v_mfma_f32_16x16x32_bf16 v[20:23], v[180:183], v[100:103], v[20:23]
  v_mfma_f32_16x16x32_bf16 v[24:27], v[180:183], v[104:107], v[24:27]
  v_mfma_f32_16x16x32_bf16 v[28:31], v[180:183], v[108:111], v[28:31]
  v_mfma_f32_16x16x32_bf16 v[32:35], v[180:183], v[112:115], v[32:35]
  v_mfma_f32_16x16x32_bf16 v[36:39], v[180:183], v[116:119], v[36:39]
  v_mfma_f32_16x16x32_bf16 v[40:43], v[184:187], v[100:103], v[40:43]
  v_mfma_f32_16x16x32_bf16 v[44:47], v[184:187], v[104:107], v[44:47]
  v_mfma_f32_16x16x32_bf16 v[48:51], v[184:187], v[108:111], v[48:51]
  v_mfma_f32_16x16x32_bf16 v[52:55], v[184:187], v[112:115], v[52:55]
  v_mfma_f32_16x16x32_bf16 v[56:59], v[184:187], v[116:119], v[56:59]
  v_mfma_f32_16x16x32_bf16 v[60:63], v[188:191], v[100:103], v[60:63]
  v_mfma_f32_16x16x32_bf16 v[64:67], v[188:191], v[104:107], v[64:67]
  v_mfma_f32_16x16x32_bf16 v[68:71], v[188:191], v[108:111], v[68:71]
  v_mfma_f32_16x16x32_bf16 v[72:75], v[188:191], v[112:115], v[72:75]
  v_mfma_f32_16x16x32_bf16 v[76:79], v[188:191], v[116:119], v[76:79]
  s_add_u32 s18, s16, 29
  s_and_b32 s18, s18, 31
  s_lshl_b32 s18, s18, 10
  buffer_load_dwordx4 v[100:103], v196, s[8:11], s18 offen
  buffer_load_dwordx4 v[104:107], v197, s[8:11], s18 offen
  buffer_load_dwordx4 v[108:111], v198, s[8:11], s18 offen
  buffer_load_dwordx4 v[112:115], v199, s[8:11], s18 offen
  buffer_load_dwordx4 v[116:119], v200, s[8:11], s18 offen
  s_waitcnt vmcnt(27)
  ds_read_b64_tr_b16 v[176:177], v192 offset:12288
  ds_read_b64_tr_b16 v[178:179], v192 offset:14336
  ds_read_b64_tr_b16 v[180:181], v193 offset:12288
  ds_read_b64_tr_b16 v[182:183], v193 offset:14336
  ds_read_b64_tr_b16 v[184:185], v194 offset:12288
  ds_read_b64_tr_b16 v[186:187], v194 offset:14336
  ds_read_b64_tr_b16 v[188:189], v195 offset:12288
  ds_read_b64_tr_b16 v[190:191], v195 offset:14336
  s_waitcnt lgkmcnt(8)
  s_add_u32 s17, s16, 31
  s_and_b32 s17, s17, 31
  s_lshl_b32 s17, s17, 15
  s_add_u32 m0, s43, 0x1000
  s_add_u32 s33, s17, 0x0
  buffer_load_dwordx4 v201, s[4:7], s33 offen lds
  s_add_u32 m0, s43, 0x1400
  s_add_u32 s33, s17, 0x2000
  buffer_load_dwordx4 v201, s[4:7], s33 offen lds
  s_add_u32 m0, s43, 0x1800
  s_add_u32 s33, s17, 0x4000
  buffer_load_dwordx4 v201, s[4:7], s33 offen lds
  s_add_u32 m0, s43, 0x1c00
  s_add_u32 s33, s17, 0x6000
  buffer_load_dwordx4 v201, s[4:7], s33 offen lds
  v_mfma_f32_16x16x32_bf16 v[0:3], v[160:163], v[120:123], v[0:3]
  v_mfma_f32_16x16x32_bf16 v[4:7], v[160:163], v[124:127], v[4:7]
  v_mfma_f32_16x16x32_bf16 v[8:11], v[160:163], v[128:131], v[8:11]
  v_mfma_f32_16x16x32_bf16 v[12:15], v[160:163], v[132:135], v[12:15]
  v_mfma_f32_16x16x32_bf16 v[16:19], v[160:163], v[136:139], v[16:19]
  v_mfma_f32_16x16x32_bf16 v[20:23], v[164:167], v[120:123], v[20:23]
  v_mfma_f32_16x16x32_bf16 v[24:27], v[164:167], v[124:127], v[24:27]
  v_mfma_f32_16x16x32_bf16 v[28:31], v[164:167], v[128:131], v[28:31]
  v_mfma_f32_16x16x32_bf16 v[32:35], v[164:167], v[132:135], v[32:35]
  v_mfma_f32_16x16x32_bf16 v[36:39], v[164:167], v[136:139], v[36:39]
  v_mfma_f32_16x16x32_bf16 v[40:43], v[168:171], v[120:123], v[40:43]
  v_mfma_f32_16x16x32_bf16 v[44:47], v[168:171], v[124:127], v[44:47]
  v_mfma_f32_16x16x32_bf16 v[48:51], v[168:171], v[128:131], v[48:51]
  v_mfma_f32_16x16x32_bf16 v[52:55], v[168:171], v[132:135], v[52:55]
  v_mfma_f32_16x16x32_bf16 v[56:59], v[168:171], v[136:139], v[56:59]
  v_mfma_f32_16x16x32_bf16 v[60:63], v[172:175], v[120:123], v[60:63]
  v_mfma_f32_16x16x32_bf16 v[64:67], v[172:175], v[124:127], v[64:67]
  v_mfma_f32_16x16x32_bf16 v[68:71], v[172:175], v[128:131], v[68:71]
  v_mfma_f32_16x16x32_bf16 v[72:75], v[172:175], v[132:135], v[72:75]
  v_mfma_f32_16x16x32_bf16 v[76:79], v[172:175], v[136:139], v[76:79]
  s_add_u32 s18, s16, 30
  s_and_b32 s18, s18, 31
  s_lshl_b32 s18, s18, 10
  buffer_load_dwordx4 v[120:123], v196, s[8:11], s18 offen
  buffer_load_dwordx4 v[124:127], v197, s[8:11], s18 offen
  buffer_load_dwordx4 v[128:131], v198, s[8:11], s18 offen
  buffer_load_dwordx4 v[132:135], v199, s[8:11], s18 offen
  buffer_load_dwordx4 v[136:139], v200, s[8:11], s18 offen
  s_waitcnt vmcnt(27)
  ds_read_b64_tr_b16 v[160:161], v192 offset:16384
  ds_read_b64_tr_b16 v[162:163], v192 offset:18432
  ds_read_b64_tr_b16 v[164:165], v193 offset:16384
  ds_read_b64_tr_b16 v[166:167], v193 offset:18432
  ds_read_b64_tr_b16 v[168:169], v194 offset:16384
  ds_read_b64_tr_b16 v[170:171], v194 offset:18432
  ds_read_b64_tr_b16 v[172:173], v195 offset:16384
  ds_read_b64_tr_b16 v[174:175], v195 offset:18432
  s_waitcnt lgkmcnt(8)
  v_mfma_f32_16x16x32_bf16 v[0:3], v[176:179], v[140:143], v[0:3]
  v_mfma_f32_16x16x32_bf16 v[4:7], v[176:179], v[144:147], v[4:7]
  v_mfma_f32_16x16x32_bf16 v[8:11], v[176:179], v[148:151], v[8:11]
  v_mfma_f32_16x16x32_bf16 v[12:15], v[176:179], v[152:155], v[12:15]
  v_mfma_f32_16x16x32_bf16 v[16:19], v[176:179], v[156:159], v[16:19]
  v_mfma_f32_16x16x32_bf16 v[20:23], v[180:183], v[140:143], v[20:23]
  v_mfma_f32_16x16x32_bf16 v[24:27], v[180:183], v[144:147], v[24:27]
  v_mfma_f32_16x16x32_bf16 v[28:31], v[180:183], v[148:151], v[28:31]
  v_mfma_f32_16x16x32_bf16 v[32:35], v[180:183], v[152:155], v[32:35]
  v_mfma_f32_16x16x32_bf16 v[36:39], v[180:183], v[156:159], v[36:39]
  v_mfma_f32_16x16x32_bf16 v[40:43], v[184:187], v[140:143], v[40:43]
  v_mfma_f32_16x16x32_bf16 v[44:47], v[184:187], v[144:147], v[44:47]
  v_mfma_f32_16x16x32_bf16 v[48:51], v[184:187], v[148:151], v[48:51]
  v_mfma_f32_16x16x32_bf16 v[52:55], v[184:187], v[152:155], v[52:55]
  v_mfma_f32_16x16x32_bf16 v[56:59], v[184:187], v[156:159], v[56:59]
  v_mfma_f32_16x16x32_bf16 v[60:63], v[188:191], v[140:143], v[60:63]
  v_mfma_f32_16x16x32_bf16 v[64:67], v[188:191], v[144:147], v[64:67]
  v_mfma_f32_16x16x32_bf16 v[68:71], v[188:191], v[148:151], v[68:71]
  v_mfma_f32_16x16x32_bf16 v[72:75], v[188:191], v[152:155], v[72:75]
  v_mfma_f32_16x16x32_bf16 v[76:79], v[188:191], v[156:159], v[76:79]
  s_add_u32 s18, s16, 31
  s_and_b32 s18, s18, 31
  s_lshl_b32 s18, s18, 10
  buffer_load_dwordx4 v[140:143], v196, s[8:11], s18 offen
  buffer_load_dwordx4 v[144:147], v197, s[8:11], s18 offen
  buffer_load_dwordx4 v[148:151], v198, s[8:11], s18 offen
  buffer_load_dwordx4 v[152:155], v199, s[8:11], s18 offen
  buffer_load_dwordx4 v[156:159], v200, s[8:11], s18 offen
  s_waitcnt vmcnt(23)
  ds_read_b64_tr_b16 v[176:177], v192 offset:20480
  ds_read_b64_tr_b16 v[178:179], v192 offset:22528
  ds_read_b64_tr_b16 v[180:181], v193 offset:20480
  ds_read_b64_tr_b16 v[182:183], v193 offset:22528
  ds_read_b64_tr_b16 v[184:185], v194 offset:20480
  ds_read_b64_tr_b16 v[186:187], v194 offset:22528
  ds_read_b64_tr_b16 v[188:189], v195 offset:20480
  ds_read_b64_tr_b16 v[190:191], v195 offset:22528
  s_waitcnt lgkmcnt(8)
  v_mfma_f32_16x16x32_bf16 v[0:3], v[160:163], v[80:83], v[0:3]
  v_mfma_f32_16x16x32_bf16 v[4:7], v[160:163], v[84:87], v[4:7]
  v_mfma_f32_16x16x32_bf16 v[8:11], v[160:163], v[88:91], v[8:11]
  v_mfma_f32_16x16x32_bf16 v[12:15], v[160:163], v[92:95], v[12:15]
  v_mfma_f32_16x16x32_bf16 v[16:19], v[160:163], v[96:99], v[16:19]
  v_mfma_f32_16x16x32_bf16 v[20:23], v[164:167], v[80:83], v[20:23]
  v_mfma_f32_16x16x32_bf16 v[24:27], v[164:167], v[84:87], v[24:27]
  v_mfma_f32_16x16x32_bf16 v[28:31], v[164:167], v[88:91], v[28:31]
  v_mfma_f32_16x16x32_bf16 v[32:35], v[164:167], v[92:95], v[32:35]
  v_mfma_f32_16x16x32_bf16 v[36:39], v[164:167], v[96:99], v[36:39]
  v_mfma_f32_16x16x32_bf16 v[40:43], v[168:171], v[80:83], v[40:43]
  v_mfma_f32_16x16x32_bf16 v[44:47], v[168:171], v[84:87], v[44:47]
  v_mfma_f32_16x16x32_bf16 v[48:51], v[168:171], v[88:91], v[48:51]
  v_mfma_f32_16x16x32_bf16 v[52:55], v[168:171], v[92:95], v[52:55]
  v_mfma_f32_16x16x32_bf16 v[56:59], v[168:171], v[96:99], v[56:59]
  v_mfma_f32_16x16x32_bf16 v[60:63], v[172:175], v[80:83], v[60:63]
  v_mfma_f32_16x16x32_bf16 v[64:67], v[172:175], v[84:87], v[64:67]
  v_mfma_f32_16x16x32_bf16 v[68:71], v[172:175], v[88:91], v[68:71]
  v_mfma_f32_16x16x32_bf16 v[72:75], v[172:175], v[92:95], v[72:75]
  v_mfma_f32_16x16x32_bf16 v[76:79], v[172:175], v[96:99], v[76:79]
  s_waitcnt vmcnt(14)
  ds_read_b64_tr_b16 v[160:161], v192 offset:0
  ds_read_b64_tr_b16 v[162:163], v192 offset:2048
  ds_read_b64_tr_b16 v[164:165], v193 offset:0
  ds_read_b64_tr_b16 v[166:167], v193 offset:2048
  ds_read_b64_tr_b16 v[168:169], v194 offset:0
  ds_read_b64_tr_b16 v[170:171], v194 offset:2048
  ds_read_b64_tr_b16 v[172:173], v195 offset:0
  ds_read_b64_tr_b16 v[174:175], v195 offset:2048
  s_waitcnt lgkmcnt(8)
  v_mfma_f32_16x16x32_bf16 v[0:3], v[176:179], v[100:103], v[0:3]
  v_mfma_f32_16x16x32_bf16 v[4:7], v[176:179], v[104:107], v[4:7]
  v_mfma_f32_16x16x32_bf16 v[8:11], v[176:179], v[108:111], v[8:11]
  v_mfma_f32_16x16x32_bf16 v[12:15], v[176:179], v[112:115], v[12:15]
  v_mfma_f32_16x16x32_bf16 v[16:19], v[176:179], v[116:119], v[16:19]
  v_mfma_f32_16x16x32_bf16 v[20:23], v[180:183], v[100:103], v[20:23]
  v_mfma_f32_16x16x32_bf16 v[24:27], v[180:183], v[104:107], v[24:27]
  v_mfma_f32_16x16x32_bf16 v[28:31], v[180:183], v[108:111], v[28:31]
  v_mfma_f32_16x16x32_bf16 v[32:35], v[180:183], v[112:115], v[32:35]
  v_mfma_f32_16x16x32_bf16 v[36:39], v[180:183], v[116:119], v[36:39]
  v_mfma_f32_16x16x32_bf16 v[40:43], v[184:187], v[100:103], v[40:43]
  v_mfma_f32_16x16x32_bf16 v[44:47], v[184:187], v[104:107], v[44:47]
  v_mfma_f32_16x16x32_bf16 v[48:51], v[184:187], v[108:111], v[48:51]
  v_mfma_f32_16x16x32_bf16 v[52:55], v[184:187], v[112:115], v[52:55]
  v_mfma_f32_16x16x32_bf16 v[56:59], v[184:187], v[116:119], v[56:59]
  v_mfma_f32_16x16x32_bf16 v[60:63], v[188:191], v[100:103], v[60:63]
  v_mfma_f32_16x16x32_bf16 v[64:67], v[188:191], v[104:107], v[64:67]
  v_mfma_f32_16x16x32_bf16 v[68:71], v[188:191], v[108:111], v[68:71]
  v_mfma_f32_16x16x32_bf16 v[72:75], v[188:191], v[112:115], v[72:75]
  v_mfma_f32_16x16x32_bf16 v[76:79], v[188:191], v[116:119], v[76:79]
  s_waitcnt vmcnt(5)
  ds_read_b64_tr_b16 v[176:177], v192 offset:4096
  ds_read_b64_tr_b16 v[178:179], v192 offset:6144
  ds_read_b64_tr_b16 v[180:181], v193 offset:4096
  ds_read_b64_tr_b16 v[182:183], v193 offset:6144
  ds_read_b64_tr_b16 v[184:185], v194 offset:4096
  ds_read_b64_tr_b16 v[186:187], v194 offset:6144
  ds_read_b64_tr_b16 v[188:189], v195 offset:4096
  ds_read_b64_tr_b16 v[190:191], v195 offset:6144
  s_waitcnt lgkmcnt(8)
  v_mfma_f32_16x16x32_bf16 v[0:3], v[160:163], v[120:123], v[0:3]
  v_mfma_f32_16x16x32_bf16 v[4:7], v[160:163], v[124:127], v[4:7]
  v_mfma_f32_16x16x32_bf16 v[8:11], v[160:163], v[128:131], v[8:11]
  v_mfma_f32_16x16x32_bf16 v[12:15], v[160:163], v[132:135], v[12:15]
  v_mfma_f32_16x16x32_bf16 v[16:19], v[160:163], v[136:139], v[16:19]
  v_mfma_f32_16x16x32_bf16 v[20:23], v[164:167], v[120:123], v[20:23]
  v_mfma_f32_16x16x32_bf16 v[24:27], v[164:167], v[124:127], v[24:27]
  v_mfma_f32_16x16x32_bf16 v[28:31], v[164:167], v[128:131], v[28:31]
  v_mfma_f32_16x16x32_bf16 v[32:35], v[164:167], v[132:135], v[32:35]
  v_mfma_f32_16x16x32_bf16 v[36:39], v[164:167], v[136:139], v[36:39]
  v_mfma_f32_16x16x32_bf16 v[40:43], v[168:171], v[120:123], v[40:43]
  v_mfma_f32_16x16x32_bf16 v[44:47], v[168:171], v[124:127], v[44:47]
  v_mfma_f32_16x16x32_bf16 v[48:51], v[168:171], v[128:131], v[48:51]
  v_mfma_f32_16x16x32_bf16 v[52:55], v[168:171], v[132:135], v[52:55]
  v_mfma_f32_16x16x32_bf16 v[56:59], v[168:171], v[136:139], v[56:59]
  v_mfma_f32_16x16x32_bf16 v[60:63], v[172:175], v[120:123], v[60:63]
  v_mfma_f32_16x16x32_bf16 v[64:67], v[172:175], v[124:127], v[64:67]
  v_mfma_f32_16x16x32_bf16 v[68:71], v[172:175], v[128:131], v[68:71]
  v_mfma_f32_16x16x32_bf16 v[72:75], v[172:175], v[132:135], v[72:75]
  v_mfma_f32_16x16x32_bf16 v[76:79], v[172:175], v[136:139], v[76:79]
  s_waitcnt vmcnt(0)
  s_waitcnt lgkmcnt(0)
  v_mfma_f32_16x16x32_bf16 v[0:3], v[176:179], v[140:143], v[0:3]
  v_mfma_f32_16x16x32_bf16 v[4:7], v[176:179], v[144:147], v[4:7]
  v_mfma_f32_16x16x32_bf16 v[8:11], v[176:179], v[148:151], v[8:11]
  v_mfma_f32_16x16x32_bf16 v[12:15], v[176:179], v[152:155], v[12:15]
  v_mfma_f32_16x16x32_bf16 v[16:19], v[176:179], v[156:159], v[16:19]
  v_mfma_f32_16x16x32_bf16 v[20:23], v[180:183], v[140:143], v[20:23]
  v_mfma_f32_16x16x32_bf16 v[24:27], v[180:183], v[144:147], v[24:27]
  v_mfma_f32_16x16x32_bf16 v[28:31], v[180:183], v[148:151], v[28:31]
  v_mfma_f32_16x16x32_bf16 v[32:35], v[180:183], v[152:155], v[32:35]
  v_mfma_f32_16x16x32_bf16 v[36:39], v[180:183], v[156:159], v[36:39]
  v_mfma_f32_16x16x32_bf16 v[40:43], v[184:187], v[140:143], v[40:43]
  v_mfma_f32_16x16x32_bf16 v[44:47], v[184:187], v[144:147], v[44:47]
  v_mfma_f32_16x16x32_bf16 v[48:51], v[184:187], v[148:151], v[48:51]
  v_mfma_f32_16x16x32_bf16 v[52:55], v[184:187], v[152:155], v[52:55]
  v_mfma_f32_16x16x32_bf16 v[56:59], v[184:187], v[156:159], v[56:59]
  v_mfma_f32_16x16x32_bf16 v[60:63], v[188:191], v[140:143], v[60:63]
  v_mfma_f32_16x16x32_bf16 v[64:67], v[188:191], v[144:147], v[64:67]
  v_mfma_f32_16x16x32_bf16 v[68:71], v[188:191], v[148:151], v[68:71]
  v_mfma_f32_16x16x32_bf16 v[72:75], v[188:191], v[152:155], v[72:75]
  v_mfma_f32_16x16x32_bf16 v[76:79], v[188:191], v[156:159], v[76:79]
  s_barrier
  s_mul_i32 s33, s24, 20480
  v_add_u32 v204, s33, v202
  s_nop 7
  ds_write_b128 v204, v[0:3] offset:0
  ds_write_b128 v204, v[4:7] offset:1024
  ds_write_b128 v204, v[8:11] offset:2048
  ds_write_b128 v204, v[12:15] offset:3072
  ds_write_b128 v204, v[16:19] offset:4096
  ds_write_b128 v204, v[20:23] offset:5120
  ds_write_b128 v204, v[24:27] offset:6144
  ds_write_b128 v204, v[28:31] offset:7168
  ds_write_b128 v204, v[32:35] offset:8192
  ds_write_b128 v204, v[36:39] offset:9216
  ds_write_b128 v204, v[40:43] offset:10240
  ds_write_b128 v204, v[44:47] offset:11264
  ds_write_b128 v204, v[48:51] offset:12288
  ds_write_b128 v204, v[52:55] offset:13312
  ds_write_b128 v204, v[56:59] offset:14336
  ds_write_b128 v204, v[60:63] offset:15360
  ds_write_b128 v204, v[64:67] offset:16384
  ds_write_b128 v204, v[68:71] offset:17408
  ds_write_b128 v204, v[72:75] offset:18432
  ds_write_b128 v204, v[76:79] offset:19456
  s_waitcnt lgkmcnt(0)
  s_barrier
  s_mul_i32 s33, s24, 5120
  v_add_u32 v204, s33, v202
  v_add_u32 v205, 0xa000, v204
  ds_read_b128 v[0:3], v204 offset:0
  ds_read_b128 v[4:7], v204 offset:20480
  ds_read_b128 v[8:11], v205 offset:0
  ds_read_b128 v[12:15], v205 offset:20480
  ds_read_b128 v[16:19], v204 offset:1024
  ds_read_b128 v[20:23], v204 offset:21504
  ds_read_b128 v[24:27], v205 offset:1024
  ds_read_b128 v[28:31], v205 offset:21504
  ds_read_b128 v[32:35], v204 offset:2048
  ds_read_b128 v[36:39], v204 offset:22528
  ds_read_b128 v[40:43], v205 offset:2048
  ds_read_b128 v[44:47], v205 offset:22528
  ds_read_b128 v[48:51], v204 offset:3072
  ds_read_b128 v[52:55], v204 offset:23552
  ds_read_b128 v[56:59], v205 offset:3072
  ds_read_b128 v[60:63], v205 offset:23552
  ds_read_b128 v[64:67], v204 offset:4096
  ds_read_b128 v[68:71], v204 offset:24576
  ds_read_b128 v[72:75], v205 offset:4096
  ds_read_b128 v[76:79], v205 offset:24576
  v_lshrrev_b32 v206, 4, v202
  v_and_b32 v207, 15, v206
  v_lshrrev_b32 v206, 4, v206
  v_lshlrev_b32 v207, 11, v207
  v_lshl_add_u32 v207, v206, 3, v207
  s_lshl_b32 s33, s24, 5
  v_add_u32 v207, s33, v207
  s_waitcnt lgkmcnt(0)
  v_add_f32 v0, v0, v4
  v_add_f32 v8, v8, v12
  v_add_f32 v0, v0, v8
  v_add_f32 v1, v1, v5
  v_add_f32 v9, v9, v13
  v_add_f32 v1, v1, v9
  v_add_f32 v2, v2, v6
  v_add_f32 v10, v10, v14
  v_add_f32 v2, v2, v10
  v_add_f32 v3, v3, v7
  v_add_f32 v11, v11, v15
  v_add_f32 v3, v3, v11
  v_cvt_pk_bf16_f32 v80, v0, v1
  v_cvt_pk_bf16_f32 v81, v2, v3
  s_mov_b32 s33, 0
  buffer_store_dwordx2 v[80:81], v207, s[12:15], s33 offen
  v_add_f32 v16, v16, v20
  v_add_f32 v24, v24, v28
  v_add_f32 v16, v16, v24
  v_add_f32 v17, v17, v21
  v_add_f32 v25, v25, v29
  v_add_f32 v17, v17, v25
  v_add_f32 v18, v18, v22
  v_add_f32 v26, v26, v30
  v_add_f32 v18, v18, v26
  v_add_f32 v19, v19, v23
  v_add_f32 v27, v27, v31
  v_add_f32 v19, v19, v27
  v_cvt_pk_bf16_f32 v82, v16, v17
  v_cvt_pk_bf16_f32 v83, v18, v19
  s_mov_b32 s33, 32768
  buffer_store_dwordx2 v[82:83], v207, s[12:15], s33 offen
  v_add_f32 v32, v32, v36
  v_add_f32 v40, v40, v44
  v_add_f32 v32, v32, v40
  v_add_f32 v33, v33, v37
  v_add_f32 v41, v41, v45
  v_add_f32 v33, v33, v41
  v_add_f32 v34, v34, v38
  v_add_f32 v42, v42, v46
  v_add_f32 v34, v34, v42
  v_add_f32 v35, v35, v39
  v_add_f32 v43, v43, v47
  v_add_f32 v35, v35, v43
  v_cvt_pk_bf16_f32 v84, v32, v33
  v_cvt_pk_bf16_f32 v85, v34, v35
  s_mov_b32 s33, 65536
  buffer_store_dwordx2 v[84:85], v207, s[12:15], s33 offen
  v_add_f32 v48, v48, v52
  v_add_f32 v56, v56, v60
  v_add_f32 v48, v48, v56
  v_add_f32 v49, v49, v53
  v_add_f32 v57, v57, v61
  v_add_f32 v49, v49, v57
  v_add_f32 v50, v50, v54
  v_add_f32 v58, v58, v62
  v_add_f32 v50, v50, v58
  v_add_f32 v51, v51, v55
  v_add_f32 v59, v59, v63
  v_add_f32 v51, v51, v59
  v_cvt_pk_bf16_f32 v86, v48, v49
  v_cvt_pk_bf16_f32 v87, v50, v51
  s_mov_b32 s33, 98304
  buffer_store_dwordx2 v[86:87], v207, s[12:15], s33 offen
  v_add_f32 v64, v64, v68
  v_add_f32 v72, v72, v76
  v_add_f32 v64, v64, v72
  v_add_f32 v65, v65, v69
  v_add_f32 v73, v73, v77
  v_add_f32 v65, v65, v73
  v_add_f32 v66, v66, v70
  v_add_f32 v74, v74, v78
  v_add_f32 v66, v66, v74
  v_add_f32 v67, v67, v71
  v_add_f32 v75, v75, v79
  v_add_f32 v67, v67, v75
  v_cvt_pk_bf16_f32 v88, v64, v65
  v_cvt_pk_bf16_f32 v89, v66, v67
  s_mov_b32 s33, 131072
  buffer_store_dwordx2 v[88:89], v207, s[12:15], s33 offen
  s_waitcnt vmcnt(0)
K2_END:
  s_endpgm
.section .rodata,"a"
.p2align 6
.amdhsa_kernel attn_kernel
  .amdhsa_next_free_vgpr 256
  .amdhsa_next_free_sgpr 72
  .amdhsa_accum_offset 256
  .amdhsa_group_segment_fixed_size 0
  .amdhsa_kernarg_size 104
  .amdhsa_user_sgpr_count 2
  .amdhsa_user_sgpr_kernarg_segment_ptr 1
  .amdhsa_system_sgpr_workgroup_id_x 1
.end_amdhsa_kernel
.p2align 6
.amdhsa_kernel oproj_kernel
  .amdhsa_next_free_vgpr 208
  .amdhsa_next_free_sgpr 72
  .amdhsa_accum_offset 208
  .amdhsa_group_segment_fixed_size 0
  .amdhsa_kernarg_size 104
  .amdhsa_user_sgpr_count 2
  .amdhsa_user_sgpr_kernarg_segment_ptr 1
  .amdhsa_system_sgpr_workgroup_id_x 1
.end_amdhsa_kernel
```
